```python
import torch

def _softmax(x, axis=-1):
    return torch.softmax(x, dim=axis)
def _gelu(x):
    return torch.nn.functional.gelu(x, approximate="tanh")
def _silu(x):
    return torch.nn.functional.silu(x)
def _sigmoid(x):
    return torch.sigmoid(x)
def _layernorm(x, axis=-1, eps=1e-5):
    m = x.mean(dim=axis, keepdim=True)
    v = x.var(dim=axis, keepdim=True, unbiased=False)
    return (x - m) / torch.sqrt(v + eps)
def _scatter_add(tgt, idx, src, axis=0):
    return tgt.clone().index_add_(axis, idx, src)
def _segment_sum(src, seg, n):
    out = torch.zeros((n,) + src.shape[1:], dtype=src.dtype)
    return out.index_add_(0, seg, src)
def _pad(x, pw):
    flat = tuple(v for pair in reversed(pw) for v in pair)
    return torch.nn.functional.pad(x, flat)

kernel_name = 'recurrent_scan__gqa_block_cached__geglu_ffn__decode'

def setup_inputs():

    _w = (lambda a: (lambda t: t.to(torch.bfloat16) if t.is_floating_point() else t)(torch.as_tensor(a)))
    def _A_setup():
        B, Sq, D = 1, 1, 512
        Hq, Hkv, Sk, Dh = 32, 8, 65536, 128
        assert Hq % Hkv == 0, (Hq, Hkv)
        return {
            "x": _w((lambda *s: torch.randn(*s, dtype=torch.bfloat16) * 0.05)(B, Sq, D)),
            "k_cache": _w((lambda *s: torch.randn(*s, dtype=torch.bfloat16) * 1.6)(B, Hkv, Sk, Dh)),
            "v_cache": _w((lambda *s: torch.randn(*s, dtype=torch.bfloat16) * 0.8)(B, Hkv, Sk, Dh)),
            "wq": _w((lambda *s: torch.randn(*s, dtype=torch.bfloat16) * 1.6)(D, Hq * Dh) * (D ** -0.5)),
            "wo": _w((lambda *s: torch.randn(*s, dtype=torch.bfloat16) * 0.8)(Hq * Dh, D) * ((Hq * Dh) ** -0.5)),
        }
    _A_in = _A_setup()

    def _B_setup():
        B, S, D, F = 1, 1, 512, 1792
        return {
            "x": _w((lambda *s: torch.randn(*s, dtype=torch.bfloat16) * 0.05)(B, S, D)),
            "w_gate": _w((lambda *s: torch.randn(*s, dtype=torch.bfloat16) * 0.2)(D, F)),
            "w_up": _w((lambda *s: torch.randn(*s, dtype=torch.bfloat16) * 0.2)(D, F)),
            "w_down": _w((lambda *s: torch.randn(*s, dtype=torch.bfloat16) * 0.2)(F, D)),
        }
    _B_in = _B_setup()

    return {
        "A_x": _A_in["x"],
        "A_k_cache": _A_in["k_cache"],
        "A_v_cache": _A_in["v_cache"],
        "A_wq": _A_in["wq"],
        "A_wo": _A_in["wo"],
        "B_x": _B_in["x"],
        "B_w_gate": _B_in["w_gate"],
        "B_w_up": _B_in["w_up"],
        "B_w_down": _B_in["w_down"],
    }

def reference(A_x, A_k_cache, A_v_cache, A_wq, A_wo, B_x, B_w_gate, B_w_up, B_w_down):
    def _A_ref(x, k_cache, v_cache, wq, wo):
        B, Sq, D = x.shape
        Hq, Dh = 32, 128
        Hkv = k_cache.shape[1]
        rep = Hq // Hkv
        q = (lambda x, *d: x.permute(*d))((x @ wq).reshape(B, Sq, Hq, Dh), 0, 2, 1, 3)
        k = (lambda x, n, axis: torch.repeat_interleave(x, n, dim=axis))(k_cache, rep, axis=1)
        v = (lambda x, n, axis: torch.repeat_interleave(x, n, dim=axis))(v_cache, rep, axis=1)
        scores = torch.einsum("bhqd,bhkd->bhqk", q, k) * (Dh ** -0.5)
        p = _softmax(scores, axis=-1)
        o = torch.einsum("bhqk,bhkd->bhqd", p, v)
        return (lambda x, *d: x.permute(*d))(o, 0, 2, 1, 3).reshape(B, Sq, Hq * Dh) @ wo

    def _B_ref(x, w_gate, w_up, w_down):
        return (_gelu(x @ w_gate) * (x @ w_up)) @ w_down

    x = A_x
    xn = _layernorm(x, axis=-1)
    s = _A_ref(xn, A_k_cache, A_v_cache, A_wq, A_wo)
    g = _silu(_B_ref(xn, B_w_gate, B_w_up, B_w_down))
    return x + s * g
```

```asm
; @launch grid=(256,1,1) block=(384,1,1) lds=163840
.amdgcn_target "amdgcn-amd-amdhsa--gfx950"
.text
.globl recurrent_scan__gqa_block_cached__geglu_ffn__decode_kernel
.p2align 8
.type recurrent_scan__gqa_block_cached__geglu_ffn__decode_kernel,@function
recurrent_scan__gqa_block_cached__geglu_ffn__decode_kernel:
    s_cmp_ge_u32 s2, 256
    s_cbranch_scc1 L_end
    s_load_dwordx16 s[4:19], s[0:1], 0
    s_load_dwordx8 s[20:27], s[0:1], 64
    v_lshrrev_b32 v1, 6, v0
    v_and_b32 v0, 63, v0
    v_readfirstlane_b32 s3, v1
    s_and_b32 s74, s2, 7
    s_lshr_b32 s50, s2, 3
    s_lshr_b32 s94, s74, 1
    s_mul_i32 s94, s94, 56
    s_and_b32 s61, s74, 1
    s_mul_i32 s62, s61, 24
    s_add_u32 s94, s94, s62
    s_cmp_eq_u32 s61, 1
    s_cselect_b32 s61, 32, 24
    s_add_u32 s51, s94, s50
    s_cmp_lt_u32 s50, s61
    s_cselect_b32 s51, s51, 0x100000
    s_mov_b32 s53, 200000
    s_mov_b32 s54, -1
    s_mov_b32 s68, 0x7fffffff
    s_xor_b32 s48, s74, 0
    s_mov_b32 s49, s50
    s_xor_b32 s95, s49, 0
    v_lshrrev_b32 v2, 4, v0
    v_and_b32 v3, 15, v0
    s_cmp_lg_u32 s3, 0
    s_cbranch_scc1 L_cons
    s_setprio 3
    v_lshlrev_b32 v20, 4, v0
    v_lshrrev_b32 v10, 2, v0
    v_lshlrev_b32 v10, 13, v10
    v_lshlrev_b32 v1, 1, v2
    v_xor_b32 v1, v1, v0
    v_and_b32 v1, 3, v1
    v_lshl_add_u32 v10, v1, 4, v10
    s_and_b32 s61, s95, 7
    s_lshl_b32 s61, s61, 7
    s_bfe_u32 s62, s95, 0x10003
    s_lshl_b32 s62, s62, 6
    s_add_u32 s61, s61, s62
    s_lshl_b32 s62, s48, 10
    s_add_u32 s61, s61, s62
    s_lshr_b32 s62, s95, 4
    s_lshl_b32 s62, s62, 21
    s_add_u32 s60, s61, s62
    v_xor_b32 v4, v2, v3
    v_lshlrev_b32 v4, 4, v4
    v_lshl_add_u32 v4, v2, 8, v4
    v_xor_b32 v5, 64, v4
    v_xor_b32 v6, 128, v4
    v_xor_b32 v7, 192, v4
    v_lshlrev_b32 v8, 1, v2
    v_xor_b32 v8, v8, v3
    v_lshlrev_b32 v8, 4, v8
    v_lshl_add_u32 v8, v2, 8, v8
    v_xor_b32 v9, 128, v8
    v_lshrrev_b32 v11, 3, v0
    v_mul_u32_u24 v11, 3584, v11
    v_lshlrev_b32 v1, 1, v2
    v_xor_b32 v1, v1, v0
    v_and_b32 v1, 7, v1
    v_lshl_add_u32 v11, v1, 4, v11
    s_and_b32 s61, s51, 7
    s_mul_i32 s61, s61, 229376
    s_lshr_b32 s63, s51, 3
    s_lshl_b32 s63, s63, 7
    s_add_u32 s63, s63, s61
    v_mov_b32 v12, 139264
    v_mov_b32 v13, 139280
    v_mov_b32 v14, -1
    v_mov_b32 v15, 0x7fffffff
    ds_write_b64 v12, v[14:15]
    s_lshl_b32 s79, s48, 24
    s_lshl_b32 s61, s49, 19
    s_add_u32 s79, s79, s61
    s_mov_b32 s59, 0
    s_bitcmp1_b32 s79, 19
    s_cselect_b32 s61, 0x20000, 0
    s_xor_b32 s79, s79, s61
    s_bitcmp1_b32 s79, 20
    s_cselect_b32 s61, 0x40000, 0
    s_xor_b32 s79, s79, s61
    s_bitcmp1_b32 s79, 22
    s_cselect_b32 s61, 0x10000, 0
    s_xor_b32 s79, s79, s61
    s_bitcmp1_b32 s79, 23
    s_cselect_b32 s61, 0x8000, 0
    s_xor_b32 s79, s79, s61
    s_mov_b32 m0, 0x22400
    s_mov_b32 s86, 0x400
    s_mov_b32 s87, 0x20000
    s_mov_b32 s38, 0x400000
    s_mov_b32 s39, 0x20000
    s_waitcnt lgkmcnt(0)
    s_mov_b64 s[84:85], s[4:5]
    buffer_load_dwordx4 v20, s[84:87], 0 offen lds
    s_mov_b64 s[36:37], s[10:11]
    s_mov_b32 m0, 0x0
    s_add_u32 s83, s60, 0
    buffer_load_dwordx4 v10, s[36:39], s83 offen offset:0 nt lds
    s_add_u32 s83, s60, 130048
    buffer_load_dwordx4 v10, s[36:39], s83 offen offset:1024 nt lds
    s_add_u32 s83, s60, 260096
    buffer_load_dwordx4 v10, s[36:39], s83 offen offset:2048 nt lds
    s_add_u32 s83, s60, 390144
    buffer_load_dwordx4 v10, s[36:39], s83 offen offset:3072 nt lds
    s_mov_b32 m0, 0x1000
    s_add_u32 s83, s60, 524288
    buffer_load_dwordx4 v10, s[36:39], s83 offen offset:0 nt lds
    s_add_u32 s83, s60, 654336
    buffer_load_dwordx4 v10, s[36:39], s83 offen offset:1024 nt lds
    s_add_u32 s83, s60, 784384
    buffer_load_dwordx4 v10, s[36:39], s83 offen offset:2048 nt lds
    s_add_u32 s83, s60, 914432
    buffer_load_dwordx4 v10, s[36:39], s83 offen offset:3072 nt lds
    s_mov_b32 m0, 0x2000
    s_add_u32 s83, s60, 1048576
    buffer_load_dwordx4 v10, s[36:39], s83 offen offset:0 nt lds
    s_add_u32 s83, s60, 1178624
    buffer_load_dwordx4 v10, s[36:39], s83 offen offset:1024 nt lds
    s_add_u32 s83, s60, 1308672
    buffer_load_dwordx4 v10, s[36:39], s83 offen offset:2048 nt lds
    s_add_u32 s83, s60, 1438720
    buffer_load_dwordx4 v10, s[36:39], s83 offen offset:3072 nt lds
    s_mov_b32 m0, 0x3000
    s_add_u32 s83, s60, 1572864
    buffer_load_dwordx4 v10, s[36:39], s83 offen offset:0 nt lds
    s_add_u32 s83, s60, 1702912
    buffer_load_dwordx4 v10, s[36:39], s83 offen offset:1024 nt lds
    s_add_u32 s83, s60, 1832960
    buffer_load_dwordx4 v10, s[36:39], s83 offen offset:2048 nt lds
    s_add_u32 s83, s60, 1963008
    buffer_load_dwordx4 v10, s[36:39], s83 offen offset:3072 nt lds
    s_mov_b32 s40, s16
    s_mov_b32 s41, s17
    s_mov_b32 s42, 0x1c0000
    s_mov_b32 s43, 0x20000
    s_mov_b32 s44, s18
    s_mov_b32 s45, s19
    s_mov_b32 s46, 0x1c0000
    s_mov_b32 s47, 0x20000
    s_mov_b32 s28, s6
    s_mov_b32 s29, s7
    s_mov_b32 s30, 0x8000000
    s_mov_b32 s31, 0x20000
    s_mov_b32 s32, s8
    s_mov_b32 s33, s9
    s_mov_b32 s34, 0x8000000
    s_mov_b32 s35, 0x20000
    s_waitcnt lgkmcnt(0)
    s_barrier
    s_waitcnt vmcnt(16)
    v_mov_b32 v14, 0
    ds_write_b32 v12, v14
    s_mov_b32 m0, 0x4000
    s_add_u32 s61, s63, 0
    buffer_load_dwordx4 v11, s[40:43], s61 offen offset:0 nt lds
    s_add_u32 s61, s63, 27648
    buffer_load_dwordx4 v11, s[40:43], s61 offen offset:1024 nt lds
    s_add_u32 s61, s63, 55296
    buffer_load_dwordx4 v11, s[40:43], s61 offen offset:2048 nt lds
    s_add_u32 s61, s63, 82944
    buffer_load_dwordx4 v11, s[40:43], s61 offen offset:3072 nt lds
    s_waitcnt vmcnt(16)
    s_mov_b32 m0, 0x5000
    s_add_u32 s61, s63, 114688
    buffer_load_dwordx4 v11, s[40:43], s61 offen offset:0 nt lds
    s_add_u32 s61, s63, 142336
    buffer_load_dwordx4 v11, s[40:43], s61 offen offset:1024 nt lds
    s_add_u32 s61, s63, 169984
    buffer_load_dwordx4 v11, s[40:43], s61 offen offset:2048 nt lds
    s_add_u32 s61, s63, 197632
    buffer_load_dwordx4 v11, s[40:43], s61 offen offset:3072 nt lds
    s_waitcnt vmcnt(16)
    v_mov_b32 v14, 1
    ds_write_b32 v12, v14
    s_mov_b32 m0, 0x6000
    s_add_u32 s61, s63, 0
    buffer_load_dwordx4 v11, s[44:47], s61 offen offset:0 nt lds
    s_add_u32 s61, s63, 27648
    buffer_load_dwordx4 v11, s[44:47], s61 offen offset:1024 nt lds
    s_add_u32 s61, s63, 55296
    buffer_load_dwordx4 v11, s[44:47], s61 offen offset:2048 nt lds
    s_add_u32 s61, s63, 82944
    buffer_load_dwordx4 v11, s[44:47], s61 offen offset:3072 nt lds
    s_waitcnt vmcnt(16)
    s_mov_b32 m0, 0x7000
    s_add_u32 s61, s63, 114688
    buffer_load_dwordx4 v11, s[44:47], s61 offen offset:0 nt lds
    s_add_u32 s61, s63, 142336
    buffer_load_dwordx4 v11, s[44:47], s61 offen offset:1024 nt lds
    s_add_u32 s61, s63, 169984
    buffer_load_dwordx4 v11, s[44:47], s61 offen offset:2048 nt lds
    s_add_u32 s61, s63, 197632
    buffer_load_dwordx4 v11, s[44:47], s61 offen offset:3072 nt lds
    s_waitcnt vmcnt(16)
    v_mov_b32 v14, 2
    ds_write_b32 v12, v14
    s_mov_b32 m0, 0x8000
    s_add_u32 s61, s59, 0
    s_xor_b32 s61, s61, s79
    buffer_load_dwordx4 v4, s[28:31], s61 offen offset:0 nt lds
    buffer_load_dwordx4 v5, s[28:31], s61 offen offset:1024 nt lds
    buffer_load_dwordx4 v6, s[28:31], s61 offen offset:2048 nt lds
    buffer_load_dwordx4 v7, s[28:31], s61 offen offset:3072 nt lds
    s_waitcnt vmcnt(16)
    s_mov_b32 m0, 0x9000
    s_add_u32 s61, s59, 4096
    s_xor_b32 s61, s61, s79
    buffer_load_dwordx4 v4, s[28:31], s61 offen offset:0 nt lds
    buffer_load_dwordx4 v5, s[28:31], s61 offen offset:1024 nt lds
    buffer_load_dwordx4 v6, s[28:31], s61 offen offset:2048 nt lds
    buffer_load_dwordx4 v7, s[28:31], s61 offen offset:3072 nt lds
    s_waitcnt vmcnt(16)
    v_mov_b32 v14, 3
    ds_write_b32 v12, v14
    s_mov_b32 m0, 0xa000
    s_add_u32 s61, s59, 8192
    s_xor_b32 s61, s61, s79
    buffer_load_dwordx4 v4, s[28:31], s61 offen offset:0 nt lds
    buffer_load_dwordx4 v5, s[28:31], s61 offen offset:1024 nt lds
    buffer_load_dwordx4 v6, s[28:31], s61 offen offset:2048 nt lds
    buffer_load_dwordx4 v7, s[28:31], s61 offen offset:3072 nt lds
    s_waitcnt vmcnt(16)
    s_mov_b32 m0, 0xb000
    s_add_u32 s61, s59, 12288
    s_xor_b32 s61, s61, s79
    buffer_load_dwordx4 v4, s[28:31], s61 offen offset:0 nt lds
    buffer_load_dwordx4 v5, s[28:31], s61 offen offset:1024 nt lds
    buffer_load_dwordx4 v6, s[28:31], s61 offen offset:2048 nt lds
    buffer_load_dwordx4 v7, s[28:31], s61 offen offset:3072 nt lds
    s_mov_b32 s60, s59
    s_add_u32 s59, s59, 16384
    s_mov_b32 s55, 6
    s_mov_b32 s56, 49152
    s_mov_b32 s58, 0
    s_mov_b32 s80, 1
    s_mov_b32 s54, 3
    s_mov_b32 s81, 0
    ds_read_b32 v21, v12 offset:12
L_ltopK:
    s_waitcnt lgkmcnt(0)
    v_readfirstlane_b32 s61, v21
    s_nop 0
    s_cmp_eq_u32 s61, 1
    s_cbranch_scc1 L_lloopK1
    s_cmp_eq_u32 s61, 2
    s_cbranch_scc1 L_lloopK2
L_lloopK0:
    s_sub_i32 s64, s55, 17
    s_cmp_gt_i32 s58, s64
    s_cbranch_scc1 L_rok_1
L_rp_2:
    ds_read_b128 v[16:19], v13
    ds_read_b32 v15, v13 offset:16
    s_sub_u32 s53, s53, 1
    s_cbranch_scc1 L_end
    s_waitcnt lgkmcnt(0)
    v_min3_i32 v16, v16, v17, v18
    v_min3_i32 v16, v16, v19, v15
    s_nop 0
    v_readfirstlane_b32 s58, v16
    s_nop 0
    s_cmp_gt_i32 s58, s64
    s_cbranch_scc0 L_rp_2
L_rok_1:
    s_waitcnt vmcnt(16)
    s_sub_u32 s61, s55, 2
    s_max_i32 s54, s54, s61
    v_mov_b32 v14, s54
    ds_write_b32 v12, v14
    s_mov_b32 m0, s56
    s_xor_b32 s61, s59, s79
    buffer_load_dwordx4 v4, s[28:31], s61 offen offset:0 nt lds
    buffer_load_dwordx4 v5, s[28:31], s61 offen offset:1024 nt lds
    buffer_load_dwordx4 v6, s[28:31], s61 offen offset:2048 nt lds
    buffer_load_dwordx4 v7, s[28:31], s61 offen offset:3072 nt lds
    s_waitcnt vmcnt(16)
    s_add_u32 m0, s56, 4096
    s_xor_b32 s61, s59, s79
    s_add_u32 s61, s61, 4096
    buffer_load_dwordx4 v4, s[28:31], s61 offen offset:0 nt lds
    buffer_load_dwordx4 v5, s[28:31], s61 offen offset:1024 nt lds
    buffer_load_dwordx4 v6, s[28:31], s61 offen offset:2048 nt lds
    buffer_load_dwordx4 v7, s[28:31], s61 offen offset:3072 nt lds
    s_add_u32 s59, s59, 8192
    s_add_u32 s55, s55, 1
    s_add_u32 s56, s56, 8192
    s_cmp_eq_u32 s56, 139264
    s_cselect_b32 s56, 0, s56
    s_sub_i32 s64, s55, 17
    s_cmp_gt_i32 s58, s64
    s_cbranch_scc1 L_rok_3
L_rp_4:
    ds_read_b128 v[16:19], v13
    ds_read_b32 v15, v13 offset:16
    s_sub_u32 s53, s53, 1
    s_cbranch_scc1 L_end
    s_waitcnt lgkmcnt(0)
    v_min3_i32 v16, v16, v17, v18
    v_min3_i32 v16, v16, v19, v15
    s_nop 0
    v_readfirstlane_b32 s58, v16
    s_nop 0
    s_cmp_gt_i32 s58, s64
    s_cbranch_scc0 L_rp_4
L_rok_3:
    s_waitcnt vmcnt(16)
    s_sub_u32 s61, s55, 2
    s_max_i32 s54, s54, s61
    v_mov_b32 v14, s54
    ds_write_b32 v12, v14
    s_mov_b32 m0, s56
    s_xor_b32 s61, s59, s79
    buffer_load_dwordx4 v4, s[28:31], s61 offen offset:0 nt lds
    buffer_load_dwordx4 v5, s[28:31], s61 offen offset:1024 nt lds
    buffer_load_dwordx4 v6, s[28:31], s61 offen offset:2048 nt lds
    buffer_load_dwordx4 v7, s[28:31], s61 offen offset:3072 nt lds
    s_waitcnt vmcnt(16)
    s_add_u32 m0, s56, 4096
    s_xor_b32 s61, s59, s79
    s_add_u32 s61, s61, 4096
    buffer_load_dwordx4 v4, s[28:31], s61 offen offset:0 nt lds
    buffer_load_dwordx4 v5, s[28:31], s61 offen offset:1024 nt lds
    buffer_load_dwordx4 v6, s[28:31], s61 offen offset:2048 nt lds
    buffer_load_dwordx4 v7, s[28:31], s61 offen offset:3072 nt lds
    ds_read_b32 v21, v12 offset:12
    s_add_u32 s59, s59, 8192
    s_add_u32 s55, s55, 1
    s_add_u32 s56, s56, 8192
    s_cmp_eq_u32 s56, 139264
    s_cselect_b32 s56, 0, s56
    s_add_u32 s80, s80, 1
    s_cmp_lt_u32 s80, 32
    s_cbranch_scc1 L_ltopK
    s_branch L_lendK
L_lloopK1:
    s_sub_i32 s64, s55, 17
    s_cmp_gt_i32 s58, s64
    s_cbranch_scc1 L_rok_5
L_rp_6:
    ds_read_b128 v[16:19], v13
    ds_read_b32 v15, v13 offset:16
    s_sub_u32 s53, s53, 1
    s_cbranch_scc1 L_end
    s_waitcnt lgkmcnt(0)
    v_min3_i32 v16, v16, v17, v18
    v_min3_i32 v16, v16, v19, v15
    s_nop 0
    v_readfirstlane_b32 s58, v16
    s_nop 0
    s_cmp_gt_i32 s58, s64
    s_cbranch_scc0 L_rp_6
L_rok_5:
    s_waitcnt vmcnt(14)
    s_sub_u32 s61, s55, 2
    s_max_i32 s54, s54, s61
    v_mov_b32 v14, s54
    ds_write_b32 v12, v14
    s_mov_b32 m0, s56
    s_xor_b32 s61, s59, s79
    buffer_load_dwordx4 v4, s[28:31], s61 offen offset:0 nt lds
    buffer_load_dwordx4 v5, s[28:31], s61 offen offset:1024 nt lds
    buffer_load_dwordx4 v6, s[28:31], s61 offen offset:2048 nt lds
    buffer_load_dwordx4 v7, s[28:31], s61 offen offset:3072 nt lds
    s_waitcnt vmcnt(14)
    s_add_u32 m0, s56, 4096
    s_xor_b32 s61, s59, s79
    s_add_u32 s61, s61, 4096
    buffer_load_dwordx4 v4, s[28:31], s61 offen offset:0 nt lds
    buffer_load_dwordx4 v5, s[28:31], s61 offen offset:1024 nt lds
    buffer_load_dwordx4 v6, s[28:31], s61 offen offset:2048 nt lds
    buffer_load_dwordx4 v7, s[28:31], s61 offen offset:3072 nt lds
    s_add_u32 s59, s59, 8192
    s_add_u32 s55, s55, 1
    s_add_u32 s56, s56, 8192
    s_cmp_eq_u32 s56, 139264
    s_cselect_b32 s56, 0, s56
    s_sub_i32 s64, s55, 17
    s_cmp_gt_i32 s58, s64
    s_cbranch_scc1 L_rok_7
L_rp_8:
    ds_read_b128 v[16:19], v13
    ds_read_b32 v15, v13 offset:16
    s_sub_u32 s53, s53, 1
    s_cbranch_scc1 L_end
    s_waitcnt lgkmcnt(0)
    v_min3_i32 v16, v16, v17, v18
    v_min3_i32 v16, v16, v19, v15
    s_nop 0
    v_readfirstlane_b32 s58, v16
    s_nop 0
    s_cmp_gt_i32 s58, s64
    s_cbranch_scc0 L_rp_8
L_rok_7:
    s_waitcnt vmcnt(14)
    s_sub_u32 s61, s55, 2
    s_max_i32 s54, s54, s61
    v_mov_b32 v14, s54
    ds_write_b32 v12, v14
    s_mov_b32 m0, s56
    s_xor_b32 s61, s59, s79
    buffer_load_dwordx4 v4, s[28:31], s61 offen offset:0 nt lds
    buffer_load_dwordx4 v5, s[28:31], s61 offen offset:1024 nt lds
    buffer_load_dwordx4 v6, s[28:31], s61 offen offset:2048 nt lds
    buffer_load_dwordx4 v7, s[28:31], s61 offen offset:3072 nt lds
    s_waitcnt vmcnt(14)
    s_add_u32 m0, s56, 4096
    s_xor_b32 s61, s59, s79
    s_add_u32 s61, s61, 4096
    buffer_load_dwordx4 v4, s[28:31], s61 offen offset:0 nt lds
    buffer_load_dwordx4 v5, s[28:31], s61 offen offset:1024 nt lds
    buffer_load_dwordx4 v6, s[28:31], s61 offen offset:2048 nt lds
    buffer_load_dwordx4 v7, s[28:31], s61 offen offset:3072 nt lds
    ds_read_b32 v21, v12 offset:12
    s_add_u32 s59, s59, 8192
    s_add_u32 s55, s55, 1
    s_add_u32 s56, s56, 8192
    s_cmp_eq_u32 s56, 139264
    s_cselect_b32 s56, 0, s56
    s_add_u32 s80, s80, 1
    s_cmp_lt_u32 s80, 32
    s_cbranch_scc1 L_ltopK
    s_branch L_lendK
L_lloopK2:
    s_sub_i32 s64, s55, 17
    s_cmp_gt_i32 s58, s64
    s_cbranch_scc1 L_rok_9
L_rp_10:
    ds_read_b128 v[16:19], v13
    ds_read_b32 v15, v13 offset:16
    s_sub_u32 s53, s53, 1
    s_cbranch_scc1 L_end
    s_waitcnt lgkmcnt(0)
    v_min3_i32 v16, v16, v17, v18
    v_min3_i32 v16, v16, v19, v15
    s_nop 0
    v_readfirstlane_b32 s58, v16
    s_nop 0
    s_cmp_gt_i32 s58, s64
    s_cbranch_scc0 L_rp_10
L_rok_9:
    s_waitcnt vmcnt(20)
    s_mov_b32 m0, s56
    s_xor_b32 s61, s59, s79
    buffer_load_dwordx4 v4, s[28:31], s61 offen offset:0 nt lds
    buffer_load_dwordx4 v5, s[28:31], s61 offen offset:1024 nt lds
    buffer_load_dwordx4 v6, s[28:31], s61 offen offset:2048 nt lds
    buffer_load_dwordx4 v7, s[28:31], s61 offen offset:3072 nt lds
    s_waitcnt vmcnt(20)
    s_sub_u32 s61, s55, 2
    s_max_i32 s54, s54, s61
    v_mov_b32 v14, s54
    ds_write_b32 v12, v14
    s_add_u32 m0, s56, 4096
    s_xor_b32 s61, s59, s79
    s_add_u32 s61, s61, 4096
    buffer_load_dwordx4 v4, s[28:31], s61 offen offset:0 nt lds
    buffer_load_dwordx4 v5, s[28:31], s61 offen offset:1024 nt lds
    buffer_load_dwordx4 v6, s[28:31], s61 offen offset:2048 nt lds
    buffer_load_dwordx4 v7, s[28:31], s61 offen offset:3072 nt lds
    s_add_u32 s59, s59, 8192
    s_add_u32 s55, s55, 1
    s_add_u32 s56, s56, 8192
    s_cmp_eq_u32 s56, 139264
    s_cselect_b32 s56, 0, s56
    s_sub_i32 s64, s55, 17
    s_cmp_gt_i32 s58, s64
    s_cbranch_scc1 L_rok_11
L_rp_12:
    ds_read_b128 v[16:19], v13
    ds_read_b32 v15, v13 offset:16
    s_sub_u32 s53, s53, 1
    s_cbranch_scc1 L_end
    s_waitcnt lgkmcnt(0)
    v_min3_i32 v16, v16, v17, v18
    v_min3_i32 v16, v16, v19, v15
    s_nop 0
    v_readfirstlane_b32 s58, v16
    s_nop 0
    s_cmp_gt_i32 s58, s64
    s_cbranch_scc0 L_rp_12
L_rok_11:
    s_waitcnt vmcnt(20)
    s_mov_b32 m0, s56
    s_xor_b32 s61, s59, s79
    buffer_load_dwordx4 v4, s[28:31], s61 offen offset:0 nt lds
    buffer_load_dwordx4 v5, s[28:31], s61 offen offset:1024 nt lds
    buffer_load_dwordx4 v6, s[28:31], s61 offen offset:2048 nt lds
    buffer_load_dwordx4 v7, s[28:31], s61 offen offset:3072 nt lds
    s_waitcnt vmcnt(20)
    s_sub_u32 s61, s55, 2
    s_max_i32 s54, s54, s61
    v_mov_b32 v14, s54
    ds_write_b32 v12, v14
    s_add_u32 m0, s56, 4096
    s_xor_b32 s61, s59, s79
    s_add_u32 s61, s61, 4096
    buffer_load_dwordx4 v4, s[28:31], s61 offen offset:0 nt lds
    buffer_load_dwordx4 v5, s[28:31], s61 offen offset:1024 nt lds
    buffer_load_dwordx4 v6, s[28:31], s61 offen offset:2048 nt lds
    buffer_load_dwordx4 v7, s[28:31], s61 offen offset:3072 nt lds
    ds_read_b32 v21, v12 offset:12
    s_add_u32 s59, s59, 8192
    s_add_u32 s55, s55, 1
    s_add_u32 s56, s56, 8192
    s_cmp_eq_u32 s56, 139264
    s_cselect_b32 s56, 0, s56
    s_add_u32 s80, s80, 1
    s_cmp_lt_u32 s80, 32
    s_cbranch_scc1 L_ltopK
L_lendK:
L_ltopV:
    s_waitcnt lgkmcnt(0)
    v_readfirstlane_b32 s61, v21
    s_nop 0
    s_cmp_eq_u32 s61, 1
    s_cbranch_scc1 L_lloopV1
    s_cmp_eq_u32 s61, 2
    s_cbranch_scc1 L_lloopV2
L_lloopV0:
    s_sub_i32 s64, s55, 17
    s_cmp_gt_i32 s58, s64
    s_cbranch_scc1 L_rok_13
L_rp_14:
    ds_read_b128 v[16:19], v13
    ds_read_b32 v15, v13 offset:16
    s_sub_u32 s53, s53, 1
    s_cbranch_scc1 L_end
    s_waitcnt lgkmcnt(0)
    v_min3_i32 v16, v16, v17, v18
    v_min3_i32 v16, v16, v19, v15
    s_nop 0
    v_readfirstlane_b32 s58, v16
    s_nop 0
    s_cmp_gt_i32 s58, s64
    s_cbranch_scc0 L_rp_14
L_rok_13:
    s_waitcnt vmcnt(16)
    s_sub_u32 s61, s55, 2
    s_max_i32 s54, s54, s61
    v_mov_b32 v14, s54
    ds_write_b32 v12, v14
    s_mov_b32 m0, s56
    s_xor_b32 s61, s60, s79
    buffer_load_dwordx4 v8, s[32:35], s61 offen offset:0 nt lds
    buffer_load_dwordx4 v9, s[32:35], s61 offen offset:1024 nt lds
    buffer_load_dwordx4 v8, s[32:35], s61 offen offset:2048 nt lds
    buffer_load_dwordx4 v9, s[32:35], s61 offen offset:3072 nt lds
    s_waitcnt vmcnt(16)
    s_add_u32 m0, s56, 4096
    s_xor_b32 s61, s60, s79
    s_add_u32 s61, s61, 4096
    buffer_load_dwordx4 v8, s[32:35], s61 offen offset:0 nt lds
    buffer_load_dwordx4 v9, s[32:35], s61 offen offset:1024 nt lds
    buffer_load_dwordx4 v8, s[32:35], s61 offen offset:2048 nt lds
    buffer_load_dwordx4 v9, s[32:35], s61 offen offset:3072 nt lds
    s_add_u32 s60, s60, 8192
    s_add_u32 s55, s55, 1
    s_add_u32 s56, s56, 8192
    s_cmp_eq_u32 s56, 139264
    s_cselect_b32 s56, 0, s56
    s_sub_i32 s64, s55, 17
    s_cmp_gt_i32 s58, s64
    s_cbranch_scc1 L_rok_15
L_rp_16:
    ds_read_b128 v[16:19], v13
    ds_read_b32 v15, v13 offset:16
    s_sub_u32 s53, s53, 1
    s_cbranch_scc1 L_end
    s_waitcnt lgkmcnt(0)
    v_min3_i32 v16, v16, v17, v18
    v_min3_i32 v16, v16, v19, v15
    s_nop 0
    v_readfirstlane_b32 s58, v16
    s_nop 0
    s_cmp_gt_i32 s58, s64
    s_cbranch_scc0 L_rp_16
L_rok_15:
    s_waitcnt vmcnt(16)
    s_sub_u32 s61, s55, 2
    s_max_i32 s54, s54, s61
    v_mov_b32 v14, s54
    ds_write_b32 v12, v14
    s_mov_b32 m0, s56
    s_xor_b32 s61, s60, s79
    buffer_load_dwordx4 v8, s[32:35], s61 offen offset:0 nt lds
    buffer_load_dwordx4 v9, s[32:35], s61 offen offset:1024 nt lds
    buffer_load_dwordx4 v8, s[32:35], s61 offen offset:2048 nt lds
    buffer_load_dwordx4 v9, s[32:35], s61 offen offset:3072 nt lds
    s_waitcnt vmcnt(16)
    s_add_u32 m0, s56, 4096
    s_xor_b32 s61, s60, s79
    s_add_u32 s61, s61, 4096
    buffer_load_dwordx4 v8, s[32:35], s61 offen offset:0 nt lds
    buffer_load_dwordx4 v9, s[32:35], s61 offen offset:1024 nt lds
    buffer_load_dwordx4 v8, s[32:35], s61 offen offset:2048 nt lds
    buffer_load_dwordx4 v9, s[32:35], s61 offen offset:3072 nt lds
    ds_read_b32 v21, v12 offset:12
    s_add_u32 s60, s60, 8192
    s_add_u32 s55, s55, 1
    s_add_u32 s56, s56, 8192
    s_cmp_eq_u32 s56, 139264
    s_cselect_b32 s56, 0, s56
    s_add_u32 s80, s80, 1
    s_cmp_lt_u32 s80, 60
    s_cbranch_scc1 L_ltopV
    s_branch L_lendV
L_lloopV1:
    s_sub_i32 s64, s55, 17
    s_cmp_gt_i32 s58, s64
    s_cbranch_scc1 L_rok_17
L_rp_18:
    ds_read_b128 v[16:19], v13
    ds_read_b32 v15, v13 offset:16
    s_sub_u32 s53, s53, 1
    s_cbranch_scc1 L_end
    s_waitcnt lgkmcnt(0)
    v_min3_i32 v16, v16, v17, v18
    v_min3_i32 v16, v16, v19, v15
    s_nop 0
    v_readfirstlane_b32 s58, v16
    s_nop 0
    s_cmp_gt_i32 s58, s64
    s_cbranch_scc0 L_rp_18
L_rok_17:
    s_waitcnt vmcnt(14)
    s_sub_u32 s61, s55, 2
    s_max_i32 s54, s54, s61
    v_mov_b32 v14, s54
    ds_write_b32 v12, v14
    s_mov_b32 m0, s56
    s_xor_b32 s61, s60, s79
    buffer_load_dwordx4 v8, s[32:35], s61 offen offset:0 nt lds
    buffer_load_dwordx4 v9, s[32:35], s61 offen offset:1024 nt lds
    buffer_load_dwordx4 v8, s[32:35], s61 offen offset:2048 nt lds
    buffer_load_dwordx4 v9, s[32:35], s61 offen offset:3072 nt lds
    s_waitcnt vmcnt(14)
    s_add_u32 m0, s56, 4096
    s_xor_b32 s61, s60, s79
    s_add_u32 s61, s61, 4096
    buffer_load_dwordx4 v8, s[32:35], s61 offen offset:0 nt lds
    buffer_load_dwordx4 v9, s[32:35], s61 offen offset:1024 nt lds
    buffer_load_dwordx4 v8, s[32:35], s61 offen offset:2048 nt lds
    buffer_load_dwordx4 v9, s[32:35], s61 offen offset:3072 nt lds
    s_add_u32 s60, s60, 8192
    s_add_u32 s55, s55, 1
    s_add_u32 s56, s56, 8192
    s_cmp_eq_u32 s56, 139264
    s_cselect_b32 s56, 0, s56
    s_sub_i32 s64, s55, 17
    s_cmp_gt_i32 s58, s64
    s_cbranch_scc1 L_rok_19
L_rp_20:
    ds_read_b128 v[16:19], v13
    ds_read_b32 v15, v13 offset:16
    s_sub_u32 s53, s53, 1
    s_cbranch_scc1 L_end
    s_waitcnt lgkmcnt(0)
    v_min3_i32 v16, v16, v17, v18
    v_min3_i32 v16, v16, v19, v15
    s_nop 0
    v_readfirstlane_b32 s58, v16
    s_nop 0
    s_cmp_gt_i32 s58, s64
    s_cbranch_scc0 L_rp_20
L_rok_19:
    s_waitcnt vmcnt(14)
    s_sub_u32 s61, s55, 2
    s_max_i32 s54, s54, s61
    v_mov_b32 v14, s54
    ds_write_b32 v12, v14
    s_mov_b32 m0, s56
    s_xor_b32 s61, s60, s79
    buffer_load_dwordx4 v8, s[32:35], s61 offen offset:0 nt lds
    buffer_load_dwordx4 v9, s[32:35], s61 offen offset:1024 nt lds
    buffer_load_dwordx4 v8, s[32:35], s61 offen offset:2048 nt lds
    buffer_load_dwordx4 v9, s[32:35], s61 offen offset:3072 nt lds
    s_waitcnt vmcnt(14)
    s_add_u32 m0, s56, 4096
    s_xor_b32 s61, s60, s79
    s_add_u32 s61, s61, 4096
    buffer_load_dwordx4 v8, s[32:35], s61 offen offset:0 nt lds
    buffer_load_dwordx4 v9, s[32:35], s61 offen offset:1024 nt lds
    buffer_load_dwordx4 v8, s[32:35], s61 offen offset:2048 nt lds
    buffer_load_dwordx4 v9, s[32:35], s61 offen offset:3072 nt lds
    ds_read_b32 v21, v12 offset:12
    s_add_u32 s60, s60, 8192
    s_add_u32 s55, s55, 1
    s_add_u32 s56, s56, 8192
    s_cmp_eq_u32 s56, 139264
    s_cselect_b32 s56, 0, s56
    s_add_u32 s80, s80, 1
    s_cmp_lt_u32 s80, 60
    s_cbranch_scc1 L_ltopV
    s_branch L_lendV
L_lloopV2:
    s_sub_i32 s64, s55, 17
    s_cmp_gt_i32 s58, s64
    s_cbranch_scc1 L_rok_21
L_rp_22:
    ds_read_b128 v[16:19], v13
    ds_read_b32 v15, v13 offset:16
    s_sub_u32 s53, s53, 1
    s_cbranch_scc1 L_end
    s_waitcnt lgkmcnt(0)
    v_min3_i32 v16, v16, v17, v18
    v_min3_i32 v16, v16, v19, v15
    s_nop 0
    v_readfirstlane_b32 s58, v16
    s_nop 0
    s_cmp_gt_i32 s58, s64
    s_cbranch_scc0 L_rp_22
L_rok_21:
    s_waitcnt vmcnt(20)
    s_mov_b32 m0, s56
    s_xor_b32 s61, s60, s79
    buffer_load_dwordx4 v8, s[32:35], s61 offen offset:0 nt lds
    buffer_load_dwordx4 v9, s[32:35], s61 offen offset:1024 nt lds
    buffer_load_dwordx4 v8, s[32:35], s61 offen offset:2048 nt lds
    buffer_load_dwordx4 v9, s[32:35], s61 offen offset:3072 nt lds
    s_waitcnt vmcnt(20)
    s_sub_u32 s61, s55, 2
    s_max_i32 s54, s54, s61
    v_mov_b32 v14, s54
    ds_write_b32 v12, v14
    s_add_u32 m0, s56, 4096
    s_xor_b32 s61, s60, s79
    s_add_u32 s61, s61, 4096
    buffer_load_dwordx4 v8, s[32:35], s61 offen offset:0 nt lds
    buffer_load_dwordx4 v9, s[32:35], s61 offen offset:1024 nt lds
    buffer_load_dwordx4 v8, s[32:35], s61 offen offset:2048 nt lds
    buffer_load_dwordx4 v9, s[32:35], s61 offen offset:3072 nt lds
    s_add_u32 s60, s60, 8192
    s_add_u32 s55, s55, 1
    s_add_u32 s56, s56, 8192
    s_cmp_eq_u32 s56, 139264
    s_cselect_b32 s56, 0, s56
    s_sub_i32 s64, s55, 17
    s_cmp_gt_i32 s58, s64
    s_cbranch_scc1 L_rok_23
L_rp_24:
    ds_read_b128 v[16:19], v13
    ds_read_b32 v15, v13 offset:16
    s_sub_u32 s53, s53, 1
    s_cbranch_scc1 L_end
    s_waitcnt lgkmcnt(0)
    v_min3_i32 v16, v16, v17, v18
    v_min3_i32 v16, v16, v19, v15
    s_nop 0
    v_readfirstlane_b32 s58, v16
    s_nop 0
    s_cmp_gt_i32 s58, s64
    s_cbranch_scc0 L_rp_24
L_rok_23:
    s_waitcnt vmcnt(20)
    s_mov_b32 m0, s56
    s_xor_b32 s61, s60, s79
    buffer_load_dwordx4 v8, s[32:35], s61 offen offset:0 nt lds
    buffer_load_dwordx4 v9, s[32:35], s61 offen offset:1024 nt lds
    buffer_load_dwordx4 v8, s[32:35], s61 offen offset:2048 nt lds
    buffer_load_dwordx4 v9, s[32:35], s61 offen offset:3072 nt lds
    s_waitcnt vmcnt(20)
    s_sub_u32 s61, s55, 2
    s_max_i32 s54, s54, s61
    v_mov_b32 v14, s54
    ds_write_b32 v12, v14
    s_add_u32 m0, s56, 4096
    s_xor_b32 s61, s60, s79
    s_add_u32 s61, s61, 4096
    buffer_load_dwordx4 v8, s[32:35], s61 offen offset:0 nt lds
    buffer_load_dwordx4 v9, s[32:35], s61 offen offset:1024 nt lds
    buffer_load_dwordx4 v8, s[32:35], s61 offen offset:2048 nt lds
    buffer_load_dwordx4 v9, s[32:35], s61 offen offset:3072 nt lds
    ds_read_b32 v21, v12 offset:12
    s_add_u32 s60, s60, 8192
    s_add_u32 s55, s55, 1
    s_add_u32 s56, s56, 8192
    s_cmp_eq_u32 s56, 139264
    s_cselect_b32 s56, 0, s56
    s_add_u32 s80, s80, 1
    s_cmp_lt_u32 s80, 60
    s_cbranch_scc1 L_ltopV
L_lendV:
    s_sub_i32 s64, s55, 17
    s_cmp_gt_i32 s58, s64
    s_cbranch_scc1 L_rok_25
L_rp_26:
    ds_read_b128 v[16:19], v13
    ds_read_b32 v15, v13 offset:16
    s_sub_u32 s53, s53, 1
    s_cbranch_scc1 L_end
    s_waitcnt lgkmcnt(0)
    v_min3_i32 v16, v16, v17, v18
    v_min3_i32 v16, v16, v19, v15
    s_nop 0
    v_readfirstlane_b32 s58, v16
    s_nop 0
    s_cmp_gt_i32 s58, s64
    s_cbranch_scc0 L_rp_26
L_rok_25:
    s_waitcnt vmcnt(20)
    s_mov_b32 m0, s56
    s_xor_b32 s61, s60, s79
    buffer_load_dwordx4 v8, s[32:35], s61 offen offset:0 nt lds
    buffer_load_dwordx4 v9, s[32:35], s61 offen offset:1024 nt lds
    buffer_load_dwordx4 v8, s[32:35], s61 offen offset:2048 nt lds
    buffer_load_dwordx4 v9, s[32:35], s61 offen offset:3072 nt lds
    s_waitcnt vmcnt(20)
    s_sub_u32 s61, s55, 2
    s_max_i32 s54, s54, s61
    v_mov_b32 v14, s54
    ds_write_b32 v12, v14
    s_add_u32 m0, s56, 4096
    s_xor_b32 s61, s60, s79
    s_add_u32 s61, s61, 4096
    buffer_load_dwordx4 v8, s[32:35], s61 offen offset:0 nt lds
    buffer_load_dwordx4 v9, s[32:35], s61 offen offset:1024 nt lds
    buffer_load_dwordx4 v8, s[32:35], s61 offen offset:2048 nt lds
    buffer_load_dwordx4 v9, s[32:35], s61 offen offset:3072 nt lds
    s_add_u32 s60, s60, 8192
    s_add_u32 s55, s55, 1
    s_add_u32 s56, s56, 8192
    s_cmp_eq_u32 s56, 139264
    s_cselect_b32 s56, 0, s56
    s_sub_i32 s64, s55, 17
    s_cmp_gt_i32 s58, s64
    s_cbranch_scc1 L_rok_27
L_rp_28:
    ds_read_b128 v[16:19], v13
    ds_read_b32 v15, v13 offset:16
    s_sub_u32 s53, s53, 1
    s_cbranch_scc1 L_end
    s_waitcnt lgkmcnt(0)
    v_min3_i32 v16, v16, v17, v18
    v_min3_i32 v16, v16, v19, v15
    s_nop 0
    v_readfirstlane_b32 s58, v16
    s_nop 0
    s_cmp_gt_i32 s58, s64
    s_cbranch_scc0 L_rp_28
L_rok_27:
    s_waitcnt vmcnt(20)
    s_mov_b32 m0, s56
    s_xor_b32 s61, s60, s79
    buffer_load_dwordx4 v8, s[32:35], s61 offen offset:0 nt lds
    buffer_load_dwordx4 v9, s[32:35], s61 offen offset:1024 nt lds
    buffer_load_dwordx4 v8, s[32:35], s61 offen offset:2048 nt lds
    buffer_load_dwordx4 v9, s[32:35], s61 offen offset:3072 nt lds
    s_waitcnt vmcnt(20)
    s_sub_u32 s61, s55, 2
    s_max_i32 s54, s54, s61
    v_mov_b32 v14, s54
    ds_write_b32 v12, v14
    s_add_u32 m0, s56, 4096
    s_xor_b32 s61, s60, s79
    s_add_u32 s61, s61, 4096
    buffer_load_dwordx4 v8, s[32:35], s61 offen offset:0 nt lds
    buffer_load_dwordx4 v9, s[32:35], s61 offen offset:1024 nt lds
    buffer_load_dwordx4 v8, s[32:35], s61 offen offset:2048 nt lds
    buffer_load_dwordx4 v9, s[32:35], s61 offen offset:3072 nt lds
    s_add_u32 s60, s60, 8192
    s_add_u32 s55, s55, 1
    s_add_u32 s56, s56, 8192
    s_cmp_eq_u32 s56, 139264
    s_cselect_b32 s56, 0, s56
    s_sub_i32 s64, s55, 17
    s_cmp_gt_i32 s58, s64
    s_cbranch_scc1 L_rok_29
L_rp_30:
    ds_read_b128 v[16:19], v13
    ds_read_b32 v15, v13 offset:16
    s_sub_u32 s53, s53, 1
    s_cbranch_scc1 L_end
    s_waitcnt lgkmcnt(0)
    v_min3_i32 v16, v16, v17, v18
    v_min3_i32 v16, v16, v19, v15
    s_nop 0
    v_readfirstlane_b32 s58, v16
    s_nop 0
    s_cmp_gt_i32 s58, s64
    s_cbranch_scc0 L_rp_30
L_rok_29:
    s_waitcnt vmcnt(20)
    s_mov_b32 m0, s56
    s_xor_b32 s61, s60, s79
    buffer_load_dwordx4 v8, s[32:35], s61 offen offset:0 nt lds
    buffer_load_dwordx4 v9, s[32:35], s61 offen offset:1024 nt lds
    buffer_load_dwordx4 v8, s[32:35], s61 offen offset:2048 nt lds
    buffer_load_dwordx4 v9, s[32:35], s61 offen offset:3072 nt lds
    s_waitcnt vmcnt(20)
    s_sub_u32 s61, s55, 2
    s_max_i32 s54, s54, s61
    v_mov_b32 v14, s54
    ds_write_b32 v12, v14
    s_add_u32 m0, s56, 4096
    s_xor_b32 s61, s60, s79
    s_add_u32 s61, s61, 4096
    buffer_load_dwordx4 v8, s[32:35], s61 offen offset:0 nt lds
    buffer_load_dwordx4 v9, s[32:35], s61 offen offset:1024 nt lds
    buffer_load_dwordx4 v8, s[32:35], s61 offen offset:2048 nt lds
    buffer_load_dwordx4 v9, s[32:35], s61 offen offset:3072 nt lds
    s_add_u32 s60, s60, 8192
    s_add_u32 s55, s55, 1
    s_add_u32 s56, s56, 8192
    s_cmp_eq_u32 s56, 139264
    s_cselect_b32 s56, 0, s56
    s_sub_i32 s64, s55, 17
    s_cmp_gt_i32 s58, s64
    s_cbranch_scc1 L_rok_31
L_rp_32:
    ds_read_b128 v[16:19], v13
    ds_read_b32 v15, v13 offset:16
    s_sub_u32 s53, s53, 1
    s_cbranch_scc1 L_end
    s_waitcnt lgkmcnt(0)
    v_min3_i32 v16, v16, v17, v18
    v_min3_i32 v16, v16, v19, v15
    s_nop 0
    v_readfirstlane_b32 s58, v16
    s_nop 0
    s_cmp_gt_i32 s58, s64
    s_cbranch_scc0 L_rp_32
L_rok_31:
    s_waitcnt vmcnt(20)
    s_mov_b32 m0, s56
    s_xor_b32 s61, s60, s79
    buffer_load_dwordx4 v8, s[32:35], s61 offen offset:0 nt lds
    buffer_load_dwordx4 v9, s[32:35], s61 offen offset:1024 nt lds
    buffer_load_dwordx4 v8, s[32:35], s61 offen offset:2048 nt lds
    buffer_load_dwordx4 v9, s[32:35], s61 offen offset:3072 nt lds
    s_waitcnt vmcnt(20)
    s_sub_u32 s61, s55, 2
    s_max_i32 s54, s54, s61
    v_mov_b32 v14, s54
    ds_write_b32 v12, v14
    s_add_u32 m0, s56, 4096
    s_xor_b32 s61, s60, s79
    s_add_u32 s61, s61, 4096
    buffer_load_dwordx4 v8, s[32:35], s61 offen offset:0 nt lds
    buffer_load_dwordx4 v9, s[32:35], s61 offen offset:1024 nt lds
    buffer_load_dwordx4 v8, s[32:35], s61 offen offset:2048 nt lds
    buffer_load_dwordx4 v9, s[32:35], s61 offen offset:3072 nt lds
    s_add_u32 s60, s60, 8192
    s_add_u32 s55, s55, 1
    s_add_u32 s56, s56, 8192
    s_cmp_eq_u32 s56, 139264
    s_cselect_b32 s56, 0, s56
    s_sub_i32 s64, s55, 17
    s_cmp_gt_i32 s58, s64
    s_cbranch_scc1 L_rok_33
L_rp_34:
    ds_read_b128 v[16:19], v13
    ds_read_b32 v15, v13 offset:16
    s_sub_u32 s53, s53, 1
    s_cbranch_scc1 L_end
    s_waitcnt lgkmcnt(0)
    v_min3_i32 v16, v16, v17, v18
    v_min3_i32 v16, v16, v19, v15
    s_nop 0
    v_readfirstlane_b32 s58, v16
    s_nop 0
    s_cmp_gt_i32 s58, s64
    s_cbranch_scc0 L_rp_34
L_rok_33:
    s_waitcnt vmcnt(20)
    s_mov_b32 m0, s56
    s_xor_b32 s61, s60, s79
    buffer_load_dwordx4 v8, s[32:35], s61 offen offset:0 nt lds
    buffer_load_dwordx4 v9, s[32:35], s61 offen offset:1024 nt lds
    buffer_load_dwordx4 v8, s[32:35], s61 offen offset:2048 nt lds
    buffer_load_dwordx4 v9, s[32:35], s61 offen offset:3072 nt lds
    s_waitcnt vmcnt(20)
    s_sub_u32 s61, s55, 2
    s_max_i32 s54, s54, s61
    v_mov_b32 v14, s54
    ds_write_b32 v12, v14
    s_add_u32 m0, s56, 4096
    s_xor_b32 s61, s60, s79
    s_add_u32 s61, s61, 4096
    buffer_load_dwordx4 v8, s[32:35], s61 offen offset:0 nt lds
    buffer_load_dwordx4 v9, s[32:35], s61 offen offset:1024 nt lds
    buffer_load_dwordx4 v8, s[32:35], s61 offen offset:2048 nt lds
    buffer_load_dwordx4 v9, s[32:35], s61 offen offset:3072 nt lds
    s_add_u32 s60, s60, 8192
    s_add_u32 s55, s55, 1
    s_add_u32 s56, s56, 8192
    s_cmp_eq_u32 s56, 139264
    s_cselect_b32 s56, 0, s56
    s_sub_i32 s64, s55, 17
    s_cmp_gt_i32 s58, s64
    s_cbranch_scc1 L_rok_35
L_rp_36:
    ds_read_b128 v[16:19], v13
    ds_read_b32 v15, v13 offset:16
    s_sub_u32 s53, s53, 1
    s_cbranch_scc1 L_end
    s_waitcnt lgkmcnt(0)
    v_min3_i32 v16, v16, v17, v18
    v_min3_i32 v16, v16, v19, v15
    s_nop 0
    v_readfirstlane_b32 s58, v16
    s_nop 0
    s_cmp_gt_i32 s58, s64
    s_cbranch_scc0 L_rp_36
L_rok_35:
    s_waitcnt vmcnt(20)
    s_mov_b32 m0, s56
    s_xor_b32 s61, s60, s79
    buffer_load_dwordx4 v8, s[32:35], s61 offen offset:0 nt lds
    buffer_load_dwordx4 v9, s[32:35], s61 offen offset:1024 nt lds
    buffer_load_dwordx4 v8, s[32:35], s61 offen offset:2048 nt lds
    buffer_load_dwordx4 v9, s[32:35], s61 offen offset:3072 nt lds
    s_waitcnt vmcnt(20)
    s_sub_u32 s61, s55, 2
    s_max_i32 s54, s54, s61
    v_mov_b32 v14, s54
    ds_write_b32 v12, v14
    s_add_u32 m0, s56, 4096
    s_xor_b32 s61, s60, s79
    s_add_u32 s61, s61, 4096
    buffer_load_dwordx4 v8, s[32:35], s61 offen offset:0 nt lds
    buffer_load_dwordx4 v9, s[32:35], s61 offen offset:1024 nt lds
    buffer_load_dwordx4 v8, s[32:35], s61 offen offset:2048 nt lds
    buffer_load_dwordx4 v9, s[32:35], s61 offen offset:3072 nt lds
    s_add_u32 s60, s60, 8192
    s_add_u32 s55, s55, 1
    s_add_u32 s56, s56, 8192
    s_cmp_eq_u32 s56, 139264
    s_cselect_b32 s56, 0, s56
    s_sub_i32 s64, s55, 17
    s_cmp_gt_i32 s58, s64
    s_cbranch_scc1 L_rok_37
L_rp_38:
    ds_read_b128 v[16:19], v13
    ds_read_b32 v15, v13 offset:16
    s_sub_u32 s53, s53, 1
    s_cbranch_scc1 L_end
    s_waitcnt lgkmcnt(0)
    v_min3_i32 v16, v16, v17, v18
    v_min3_i32 v16, v16, v19, v15
    s_nop 0
    v_readfirstlane_b32 s58, v16
    s_nop 0
    s_cmp_gt_i32 s58, s64
    s_cbranch_scc0 L_rp_38
L_rok_37:
    s_waitcnt vmcnt(20)
    s_mov_b32 m0, s56
    s_xor_b32 s61, s60, s79
    buffer_load_dwordx4 v8, s[32:35], s61 offen offset:0 nt lds
    buffer_load_dwordx4 v9, s[32:35], s61 offen offset:1024 nt lds
    buffer_load_dwordx4 v8, s[32:35], s61 offen offset:2048 nt lds
    buffer_load_dwordx4 v9, s[32:35], s61 offen offset:3072 nt lds
    s_waitcnt vmcnt(20)
    s_sub_u32 s61, s55, 2
    s_max_i32 s54, s54, s61
    v_mov_b32 v14, s54
    ds_write_b32 v12, v14
    s_add_u32 m0, s56, 4096
    s_xor_b32 s61, s60, s79
    s_add_u32 s61, s61, 4096
    buffer_load_dwordx4 v8, s[32:35], s61 offen offset:0 nt lds
    buffer_load_dwordx4 v9, s[32:35], s61 offen offset:1024 nt lds
    buffer_load_dwordx4 v8, s[32:35], s61 offen offset:2048 nt lds
    buffer_load_dwordx4 v9, s[32:35], s61 offen offset:3072 nt lds
    s_add_u32 s60, s60, 8192
    s_add_u32 s55, s55, 1
    s_add_u32 s56, s56, 8192
    s_cmp_eq_u32 s56, 139264
    s_cselect_b32 s56, 0, s56
    s_sub_i32 s64, s55, 17
    s_cmp_gt_i32 s58, s64
    s_cbranch_scc1 L_rok_39
L_rp_40:
    ds_read_b128 v[16:19], v13
    ds_read_b32 v15, v13 offset:16
    s_sub_u32 s53, s53, 1
    s_cbranch_scc1 L_end
    s_waitcnt lgkmcnt(0)
    v_min3_i32 v16, v16, v17, v18
    v_min3_i32 v16, v16, v19, v15
    s_nop 0
    v_readfirstlane_b32 s58, v16
    s_nop 0
    s_cmp_gt_i32 s58, s64
    s_cbranch_scc0 L_rp_40
L_rok_39:
    s_waitcnt vmcnt(20)
    s_mov_b32 m0, s56
    s_xor_b32 s61, s60, s79
    buffer_load_dwordx4 v8, s[32:35], s61 offen offset:0 nt lds
    buffer_load_dwordx4 v9, s[32:35], s61 offen offset:1024 nt lds
    buffer_load_dwordx4 v8, s[32:35], s61 offen offset:2048 nt lds
    buffer_load_dwordx4 v9, s[32:35], s61 offen offset:3072 nt lds
    s_waitcnt vmcnt(20)
    s_sub_u32 s61, s55, 2
    s_max_i32 s54, s54, s61
    v_mov_b32 v14, s54
    ds_write_b32 v12, v14
    s_add_u32 m0, s56, 4096
    s_xor_b32 s61, s60, s79
    s_add_u32 s61, s61, 4096
    buffer_load_dwordx4 v8, s[32:35], s61 offen offset:0 nt lds
    buffer_load_dwordx4 v9, s[32:35], s61 offen offset:1024 nt lds
    buffer_load_dwordx4 v8, s[32:35], s61 offen offset:2048 nt lds
    buffer_load_dwordx4 v9, s[32:35], s61 offen offset:3072 nt lds
    s_add_u32 s60, s60, 8192
    s_add_u32 s55, s55, 1
    s_add_u32 s56, s56, 8192
    s_cmp_eq_u32 s56, 139264
    s_cselect_b32 s56, 0, s56
    v_mov_b32 v15, 0
    ds_write_b32 v12, v15 offset:4
    s_mov_b32 s20, s12
    s_mov_b32 s21, s13
    s_mov_b32 s22, 0x400000
    s_mov_b32 s23, 0x20000
    v_and_b32 v4, 0xff, v8
    v_lshl_add_u32 v4, v2, 10, v4
    v_xor_b32 v5, 128, v4
    v_lshlrev_b32 v6, 10, v0
    s_and_b32 s61, s49, 28
    s_lshl_b32 s62, s48, 5
    s_add_u32 s61, s61, s62
    s_lshl_b32 s61, s61, 14
    s_and_b32 s62, s49, 3
    s_lshl_b32 s62, s62, 8
    s_add_u32 s59, s61, s62
    s_mov_b32 s55, 133
    s_sub_i32 s64, s55, 17
    s_cmp_gt_i32 s58, s64
    s_cbranch_scc1 L_rok_41
L_rp_42:
    ds_read_b128 v[16:19], v13
    ds_read_b32 v15, v13 offset:16
    s_sub_u32 s53, s53, 1
    s_cbranch_scc1 L_end
    s_waitcnt lgkmcnt(0)
    v_min3_i32 v16, v16, v17, v18
    v_min3_i32 v16, v16, v19, v15
    s_nop 0
    v_readfirstlane_b32 s58, v16
    s_nop 0
    s_cmp_gt_i32 s58, s64
    s_cbranch_scc0 L_rp_42
L_rok_41:
    v_mov_b32 v14, 130
    s_waitcnt vmcnt(16)
    ds_write_b32 v12, v14
    s_waitcnt vmcnt(12)
    s_mov_b32 m0, 0x1a000
    s_add_u32 s61, s59, 0
    buffer_load_dwordx4 v4, s[20:23], s61 offen offset:0 nt lds
    s_add_u32 s61, s59, 3072
    buffer_load_dwordx4 v5, s[20:23], s61 offen offset:1024 nt lds
    s_add_u32 s61, s59, 6144
    buffer_load_dwordx4 v4, s[20:23], s61 offen offset:2048 nt lds
    s_add_u32 s61, s59, 9216
    buffer_load_dwordx4 v5, s[20:23], s61 offen offset:3072 nt lds
    s_mov_b32 m0, 0x1b000
    s_add_u32 s61, s59, 16384
    buffer_load_dwordx4 v4, s[20:23], s61 offen offset:0 nt lds
    s_add_u32 s61, s59, 19456
    buffer_load_dwordx4 v5, s[20:23], s61 offen offset:1024 nt lds
    s_add_u32 s61, s59, 22528
    buffer_load_dwordx4 v4, s[20:23], s61 offen offset:2048 nt lds
    s_add_u32 s61, s59, 25600
    buffer_load_dwordx4 v5, s[20:23], s61 offen offset:3072 nt lds
    s_mov_b32 m0, 0x1c000
    s_add_u32 s61, s59, 32768
    buffer_load_dwordx4 v4, s[20:23], s61 offen offset:0 nt lds
    s_add_u32 s61, s59, 35840
    buffer_load_dwordx4 v5, s[20:23], s61 offen offset:1024 nt lds
    s_add_u32 s61, s59, 38912
    buffer_load_dwordx4 v4, s[20:23], s61 offen offset:2048 nt lds
    s_add_u32 s61, s59, 41984
    buffer_load_dwordx4 v5, s[20:23], s61 offen offset:3072 nt lds
    s_mov_b32 m0, 0x1d000
    s_add_u32 s61, s59, 49152
    buffer_load_dwordx4 v4, s[20:23], s61 offen offset:0 nt lds
    s_add_u32 s61, s59, 52224
    buffer_load_dwordx4 v5, s[20:23], s61 offen offset:1024 nt lds
    s_add_u32 s61, s59, 55296
    buffer_load_dwordx4 v4, s[20:23], s61 offen offset:2048 nt lds
    s_add_u32 s61, s59, 58368
    buffer_load_dwordx4 v5, s[20:23], s61 offen offset:3072 nt lds
    v_mov_b32 v14, 131
    s_waitcnt vmcnt(24)
    ds_write_b32 v12, v14
    v_mov_b32 v14, 132
    s_waitcnt vmcnt(16)
    ds_write_b32 v12, v14
    v_mov_b32 v14, 133
    s_waitcnt vmcnt(8)
    ds_write_b32 v12, v14
    v_mov_b32 v14, 134
    s_waitcnt vmcnt(0)
    ds_write_b32 v12, v14
    s_endpgm
L_cons:
    s_sub_u32 s69, s3, 1
    v_mov_b32 v4, 139264
    s_lshl_b32 s61, s69, 2
    s_add_u32 s61, s61, 139280
    v_mov_b32 v5, s61
    s_add_u32 s55, s69, 4
    s_cmp_eq_u32 s69, 0
    s_cselect_b32 s61, 0, s55
    s_cmp_eq_u32 s69, 4
    s_cselect_b32 s61, 2, s61
    v_mov_b32 v1, s61
    ds_write_b32 v5, v1
    v_mov_b32 v1, 0
    ds_write_b32 v4, v1 offset:8
    ds_write_b32 v4, v1 offset:12
    ds_write_b32 v5, v1 offset:48
    ds_write_b32 v5, v1 offset:80
    s_mov_b32 s65, 0x3db504f3
    s_mov_b32 s66, 0x3fb8aa3b
    v_mov_b32 v157, 0x3ff
    v_xor_b32 v6, v2, v3
    v_lshlrev_b32 v6, 4, v6
    v_lshl_add_u32 v6, v3, 8, v6
    v_lshrrev_b32 v1, 2, v3
    v_lshl_add_u32 v1, v2, 2, v1
    v_and_b32 v7, 7, v1
    v_lshlrev_b32 v7, 5, v7
    v_lshl_add_u32 v7, v1, 8, v7
    v_and_b32 v11, 3, v0
    v_lshl_add_u32 v7, v11, 3, v7
    v_lshlrev_b32 v156, 4, v0
    s_lshl_b32 s81, s74, 4
    s_add_u32 s81, s81, s50
    s_waitcnt lgkmcnt(0)
    s_load_dword s52, s[26:27], 0
    s_and_b32 s61, s81, 127
    s_lshl_b32 s61, s61, 3
    s_load_dwordx2 s[76:77], s[4:5], s61
    s_mov_b32 s28, s26
    s_mov_b32 s29, s27
    s_mov_b32 s30, 0x600000
    s_mov_b32 s31, 0x20000
    s_mov_b32 s36, s20
    s_mov_b32 s37, s21
    s_mov_b32 s38, 0x1c0000
    s_mov_b32 s39, 0x20000
    s_mov_b32 s40, s12
    s_mov_b32 s41, s13
    s_mov_b32 s42, 0x400000
    s_mov_b32 s43, 0x20000
    s_mov_b32 s44, s22
    s_mov_b32 s45, s23
    s_mov_b32 s46, 0x400
    s_mov_b32 s47, 0x20000
    s_barrier
    s_and_b32 s61, s69, 3
    s_cmp_eq_u32 s61, 0
    s_cbranch_scc1 L_ln
    s_cmp_ge_u32 s69, 3
    s_cbranch_scc0 L_waitq
    s_lshl_b32 s61, s50, 15
    s_lshl_b32 s62, s74, 9
    s_add_u32 s61, s61, s62
    s_and_b32 s62, s69, 1
    s_lshl_b32 s62, s62, 8
    s_add_u32 s61, s61, s62
    s_add_u32 s59, s61, 0x500000
    s_add_u32 s60, s59, 0x2000
    s_getreg_b32 s82, hwreg(HW_REG_XCC_ID, 2, 1)
    s_mov_b32 s61, 0
    s_mov_b32 s63, s82
    s_and_b32 s62, s50, 1
    s_xor_b32 s63, s63, s62
    s_lshl_b32 s62, s62, 13
    s_add_u32 s59, s59, s62
    s_xor_b32 s60, s59, 0x2000
    s_load_dword s62, s[26:27], s59 offset:0x40
    s_waitcnt lgkmcnt(0)
    s_load_dword s84, s[26:27], s59 offset:0x0
L_sp_43:
    s_sub_u32 s61, s61, 1
    s_sub_u32 s53, s53, 1
    s_cbranch_scc1 L_end
    s_getreg_b32 s62, hwreg(HW_REG_IB_STS, 8, 4)
    s_cmp_lg_u32 s62, 0
    s_cbranch_scc1 L_sp_43
    s_load_dword s84, s[26:27], s60 offset:0x0
L_sp_44:
    s_add_u32 s61, s61, 1
    s_sub_u32 s53, s53, 1
    s_cbranch_scc1 L_end
    s_getreg_b32 s62, hwreg(HW_REG_IB_STS, 8, 4)
    s_cmp_lg_u32 s62, 0
    s_cbranch_scc1 L_sp_44
    s_load_dword s84, s[26:27], s59 offset:0x1000
L_sp_45:
    s_sub_u32 s61, s61, 1
    s_sub_u32 s53, s53, 1
    s_cbranch_scc1 L_end
    s_getreg_b32 s62, hwreg(HW_REG_IB_STS, 8, 4)
    s_cmp_lg_u32 s62, 0
    s_cbranch_scc1 L_sp_45
    s_load_dword s84, s[26:27], s60 offset:0x1000
L_sp_46:
    s_add_u32 s61, s61, 1
    s_sub_u32 s53, s53, 1
    s_cbranch_scc1 L_end
    s_getreg_b32 s62, hwreg(HW_REG_IB_STS, 8, 4)
    s_cmp_lg_u32 s62, 0
    s_cbranch_scc1 L_sp_46
    s_ashr_i32 s61, s61, 1
    s_min_i32 s61, s61, 7
    s_max_i32 s61, s61, -7
    s_sub_u32 s62, 0, s61
    s_cmp_eq_u32 s63, 0
    s_cselect_b32 s61, s61, s62
    s_add_u32 s61, s61, 8
    s_lshl_b32 s82, s82, 7
    s_add_u32 s61, s61, s82
    s_add_u32 s62, s52, 1
    s_lshl_b32 s62, s62, 8
    s_add_u32 s61, s61, s62
    v_mov_b32 v20, s61
    s_lshl_b32 s61, s74, 5
    s_add_u32 s61, s61, s50
    s_lshl_b32 s61, s61, 2
    s_sub_u32 s62, 3, s69
    s_lshl_b32 s62, s62, 10
    s_add_u32 s61, s61, s62
    s_add_u32 s61, s61, 0x50000
    s_mov_b64 exec, 1
    buffer_store_dword v20, off, s[28:31], s61
    s_mov_b64 exec, -1
L_waitq:
    ds_read_b32 v20, v4 offset:8
    s_sub_u32 s53, s53, 1
    s_cbranch_scc1 L_end
    s_waitcnt lgkmcnt(0)
    v_readfirstlane_b32 s78, v20
    s_nop 0
    s_cmp_eq_u32 s78, 0
    s_cbranch_scc1 L_waitq
    s_add_u32 s52, s52, 1
    s_bfe_u32 s67, s52, 0xa000a
    s_and_b32 s75, s52, 0x3ff
    s_branch L_qready
L_ln:
    s_cmp_gt_i32 s54, -1
    s_cbranch_scc1 L_fok_47
L_fp_48:
    ds_read_b64 v[144:145], v4
    s_sub_u32 s53, s53, 1
    s_cbranch_scc1 L_end
    s_waitcnt lgkmcnt(0)
    v_readfirstlane_b32 s54, v144
    v_readfirstlane_b32 s68, v145
    s_cmp_gt_i32 s54, -1
    s_cbranch_scc0 L_fp_48
L_fok_47:
    v_add_u32 v144, 140288, v156
    ds_read_b128 v[60:63], v144
    s_add_u32 s52, s52, 1
    s_bfe_u32 s67, s52, 0xa000a
    s_and_b32 s75, s52, 0x3ff
    s_waitcnt lgkmcnt(0)
    v_lshlrev_b32 v64, 16, v60
    v_and_b32 v65, 0xffff0000, v60
    v_lshlrev_b32 v66, 16, v61
    v_and_b32 v67, 0xffff0000, v61
    v_lshlrev_b32 v68, 16, v62
    v_and_b32 v69, 0xffff0000, v62
    v_lshlrev_b32 v70, 16, v63
    v_and_b32 v71, 0xffff0000, v63
    v_add_f32 v72, v64, v65
    v_add_f32 v73, v66, v67
    v_add_f32 v74, v68, v69
    v_add_f32 v72, v72, v73
    v_add_f32 v73, v70, v71
    v_add_f32 v72, v72, v74
    v_add_f32 v72, v72, v73
    s_nop 1
    v_add_f32_dpp v72, v72, v72 row_ror:8 row_mask:0xf bank_mask:0xf
    s_nop 1
    v_add_f32_dpp v72, v72, v72 row_ror:4 row_mask:0xf bank_mask:0xf
    s_nop 1
    v_add_f32_dpp v72, v72, v72 row_ror:2 row_mask:0xf bank_mask:0xf
    s_nop 1
    v_add_f32_dpp v72, v72, v72 row_ror:1 row_mask:0xf bank_mask:0xf
    v_mov_b32 v73, v72
    s_nop 1
    v_permlane16_swap_b32 v72, v73
    v_add_f32 v72, v72, v73
    v_mov_b32 v73, v72
    s_nop 1
    v_permlane32_swap_b32 v72, v73
    v_add_f32 v72, v72, v73
    v_mul_f32 v72, 0x3b000000, v72
    v_sub_f32 v76, v64, v72
    v_sub_f32 v77, v65, v72
    v_sub_f32 v78, v66, v72
    v_sub_f32 v79, v67, v72
    v_sub_f32 v80, v68, v72
    v_sub_f32 v81, v69, v72
    v_sub_f32 v82, v70, v72
    v_sub_f32 v83, v71, v72
    v_mul_f32 v74, v76, v76
    v_fmac_f32 v74, v77, v77
    v_fmac_f32 v74, v78, v78
    v_fmac_f32 v74, v79, v79
    v_fmac_f32 v74, v80, v80
    v_fmac_f32 v74, v81, v81
    v_fmac_f32 v74, v82, v82
    v_fmac_f32 v74, v83, v83
    s_nop 1
    v_add_f32_dpp v74, v74, v74 row_ror:8 row_mask:0xf bank_mask:0xf
    s_nop 1
    v_add_f32_dpp v74, v74, v74 row_ror:4 row_mask:0xf bank_mask:0xf
    s_nop 1
    v_add_f32_dpp v74, v74, v74 row_ror:2 row_mask:0xf bank_mask:0xf
    s_nop 1
    v_add_f32_dpp v74, v74, v74 row_ror:1 row_mask:0xf bank_mask:0xf
    v_mov_b32 v73, v74
    s_nop 1
    v_permlane16_swap_b32 v74, v73
    v_add_f32 v74, v74, v73
    v_mov_b32 v73, v74
    s_nop 1
    v_permlane32_swap_b32 v74, v73
    v_add_f32 v74, v74, v73
    v_mul_f32 v74, 0x3b000000, v74
    v_cvt_pk_bf16_f32 v72, v72, v72
    v_and_b32 v72, 0xffff0000, v72
    v_cvt_pk_bf16_f32 v74, v74, v74
    v_and_b32 v74, 0xffff0000, v74
    v_add_f32 v74, 0x3727c5ac, v74
    v_cvt_pk_bf16_f32 v74, v74, v74
    v_and_b32 v74, 0xffff0000, v74
    v_sqrt_f32 v74, v74
    s_nop 0
    v_cvt_pk_bf16_f32 v74, v74, v74
    v_and_b32 v74, 0xffff0000, v74
    v_rcp_f32 v74, v74
    v_sub_f32 v76, v64, v72
    v_sub_f32 v77, v65, v72
    v_sub_f32 v78, v66, v72
    v_sub_f32 v79, v67, v72
    v_sub_f32 v80, v68, v72
    v_sub_f32 v81, v69, v72
    v_sub_f32 v82, v70, v72
    v_sub_f32 v83, v71, v72
    v_cvt_pk_bf16_f32 v60, v76, v77
    v_cvt_pk_bf16_f32 v61, v78, v79
    v_cvt_pk_bf16_f32 v62, v80, v81
    v_cvt_pk_bf16_f32 v63, v82, v83
    v_lshlrev_b32 v76, 16, v60
    v_and_b32 v77, 0xffff0000, v60
    v_lshlrev_b32 v78, 16, v61
    v_and_b32 v79, 0xffff0000, v61
    v_lshlrev_b32 v80, 16, v62
    v_and_b32 v81, 0xffff0000, v62
    v_lshlrev_b32 v82, 16, v63
    v_and_b32 v83, 0xffff0000, v63
    v_mul_f32 v76, v76, v74
    v_mul_f32 v77, v77, v74
    v_mul_f32 v78, v78, v74
    v_mul_f32 v79, v79, v74
    v_mul_f32 v80, v80, v74
    v_mul_f32 v81, v81, v74
    v_mul_f32 v82, v82, v74
    v_mul_f32 v83, v83, v74
    v_cvt_pk_bf16_f32 v60, v76, v77
    v_cvt_pk_bf16_f32 v61, v78, v79
    v_cvt_pk_bf16_f32 v62, v80, v81
    v_cvt_pk_bf16_f32 v63, v82, v83
    s_lshl_b32 s61, s69, 8
    s_add_u32 s61, s61, 141312
    v_add_u32 v72, s61, v156
    ds_write_b128 v72, v[60:63]
    s_cmp_eq_u32 s69, 0
    s_cbranch_scc0 L_help
    s_lshr_b32 s62, s95, 4
    s_lshl_b32 s62, s62, 9
    s_add_u32 s61, s61, s62
    v_lshl_add_u32 v72, v2, 3, s61
    ds_read2_b64 v[92:95], v72 offset0:0 offset1:4
    ds_read2_b64 v[96:99], v72 offset0:8 offset1:12
    ds_read2_b64 v[100:103], v72 offset0:16 offset1:20
    ds_read2_b64 v[104:107], v72 offset0:24 offset1:28
    ds_read2_b64 v[108:111], v72 offset0:32 offset1:36
    ds_read2_b64 v[112:115], v72 offset0:40 offset1:44
    ds_read2_b64 v[116:119], v72 offset0:48 offset1:52
    ds_read2_b64 v[120:123], v72 offset0:56 offset1:60
    v_lshlrev_b32 v144, 6, v1
    v_lshl_add_u32 v144, v11, 3, v144
    v_and_b32 v145, 1, v2
    v_lshl_add_u32 v144, v145, 5, v144
    v_xor_b32 v145, 32, v144
    s_getreg_b32 s82, hwreg(HW_REG_XCC_ID, 0, 4)
    s_waitcnt lgkmcnt(2)
    s_cmp_gt_i32 s54, 0
    s_cbranch_scc1 L_fok_49
L_fp_50:
    ds_read_b64 v[146:147], v4
    s_sub_u32 s53, s53, 1
    s_cbranch_scc1 L_end
    s_waitcnt lgkmcnt(0)
    v_readfirstlane_b32 s54, v146
    v_readfirstlane_b32 s68, v147
    s_cmp_gt_i32 s54, 0
    s_cbranch_scc0 L_fp_50
L_fok_49:
    ds_read_b64_tr_b16 v[60:61], v144 offset:0
    ds_read_b64_tr_b16 v[62:63], v144 offset:1024
    ds_read_b64_tr_b16 v[64:65], v145 offset:0
    ds_read_b64_tr_b16 v[66:67], v145 offset:1024
    ds_read_b64_tr_b16 v[68:69], v144 offset:2048
    ds_read_b64_tr_b16 v[70:71], v144 offset:3072
    ds_read_b64_tr_b16 v[72:73], v145 offset:2048
    ds_read_b64_tr_b16 v[74:75], v145 offset:3072
    ds_read_b64_tr_b16 v[76:77], v144 offset:4096
    ds_read_b64_tr_b16 v[78:79], v144 offset:5120
    ds_read_b64_tr_b16 v[80:81], v145 offset:4096
    ds_read_b64_tr_b16 v[82:83], v145 offset:5120
    s_waitcnt lgkmcnt(10)
    v_mfma_f32_16x16x32_bf16 v[12:15], v[60:63], v[92:95], 0
    ds_read_b64_tr_b16 v[84:85], v144 offset:6144
    ds_read_b64_tr_b16 v[86:87], v144 offset:7168
    s_waitcnt lgkmcnt(10)
    v_mfma_f32_16x16x32_bf16 v[16:19], v[64:67], v[92:95], 0
    ds_read_b64_tr_b16 v[88:89], v145 offset:6144
    ds_read_b64_tr_b16 v[90:91], v145 offset:7168
    s_waitcnt lgkmcnt(10)
    v_mfma_f32_16x16x32_bf16 v[12:15], v[68:71], v[96:99], v[12:15]
    s_waitcnt lgkmcnt(8)
    v_mfma_f32_16x16x32_bf16 v[16:19], v[72:75], v[96:99], v[16:19]
    s_waitcnt lgkmcnt(6)
    v_mfma_f32_16x16x32_bf16 v[12:15], v[76:79], v[100:103], v[12:15]
    s_waitcnt lgkmcnt(4)
    v_mfma_f32_16x16x32_bf16 v[16:19], v[80:83], v[100:103], v[16:19]
    s_waitcnt lgkmcnt(2)
    v_mfma_f32_16x16x32_bf16 v[12:15], v[84:87], v[104:107], v[12:15]
    s_waitcnt lgkmcnt(0)
    v_mfma_f32_16x16x32_bf16 v[16:19], v[88:91], v[104:107], v[16:19]
    s_cmp_gt_i32 s54, 1
    s_cbranch_scc1 L_fok_51
L_fp_52:
    ds_read_b64 v[146:147], v4
    s_sub_u32 s53, s53, 1
    s_cbranch_scc1 L_end
    s_waitcnt lgkmcnt(0)
    v_readfirstlane_b32 s54, v146
    v_readfirstlane_b32 s68, v147
    s_cmp_gt_i32 s54, 1
    s_cbranch_scc0 L_fp_52
L_fok_51:
    ds_read_b64_tr_b16 v[60:61], v144 offset:8192
    ds_read_b64_tr_b16 v[62:63], v144 offset:9216
    ds_read_b64_tr_b16 v[64:65], v145 offset:8192
    ds_read_b64_tr_b16 v[66:67], v145 offset:9216
    ds_read_b64_tr_b16 v[68:69], v144 offset:10240
    ds_read_b64_tr_b16 v[70:71], v144 offset:11264
    ds_read_b64_tr_b16 v[72:73], v145 offset:10240
    ds_read_b64_tr_b16 v[74:75], v145 offset:11264
    ds_read_b64_tr_b16 v[76:77], v144 offset:12288
    ds_read_b64_tr_b16 v[78:79], v144 offset:13312
    ds_read_b64_tr_b16 v[80:81], v145 offset:12288
    ds_read_b64_tr_b16 v[82:83], v145 offset:13312
    s_waitcnt lgkmcnt(10)
    v_mfma_f32_16x16x32_bf16 v[12:15], v[60:63], v[108:111], v[12:15]
    ds_read_b64_tr_b16 v[84:85], v144 offset:14336
    ds_read_b64_tr_b16 v[86:87], v144 offset:15360
    s_waitcnt lgkmcnt(10)
    v_mfma_f32_16x16x32_bf16 v[16:19], v[64:67], v[108:111], v[16:19]
    ds_read_b64_tr_b16 v[88:89], v145 offset:14336
    ds_read_b64_tr_b16 v[90:91], v145 offset:15360
    s_waitcnt lgkmcnt(10)
    v_mfma_f32_16x16x32_bf16 v[12:15], v[68:71], v[112:115], v[12:15]
    s_waitcnt lgkmcnt(8)
    v_mfma_f32_16x16x32_bf16 v[16:19], v[72:75], v[112:115], v[16:19]
    s_waitcnt lgkmcnt(6)
    v_mfma_f32_16x16x32_bf16 v[12:15], v[76:79], v[116:119], v[12:15]
    s_waitcnt lgkmcnt(4)
    v_mfma_f32_16x16x32_bf16 v[16:19], v[80:83], v[116:119], v[16:19]
    s_waitcnt lgkmcnt(2)
    v_mfma_f32_16x16x32_bf16 v[12:15], v[84:87], v[120:123], v[12:15]
    s_waitcnt lgkmcnt(0)
    v_mfma_f32_16x16x32_bf16 v[16:19], v[88:91], v[120:123], v[16:19]
    v_mov_b32 v20, 4
    ds_write_b32 v5, v20
    s_and_b32 s61, s95, 7
    s_lshl_b32 s61, s61, 8
    s_bfe_u32 s62, s95, 0x10003
    s_lshl_b32 s62, s62, 7
    s_add_u32 s61, s61, s62
    s_lshr_b32 s62, s95, 4
    s_lshl_b32 s62, s62, 11
    s_add_u32 s61, s61, s62
    s_lshl_b32 s59, s48, 12
    s_add_u32 s59, s59, 0x10000
    s_add_u32 s61, s61, s59
    v_lshlrev_b32 v144, 4, v2
    v_lshl_add_u32 v144, v3, 6, v144
    v_add_u32 v144, s61, v144
    s_lshl_b32 s60, s48, 9
    s_add_u32 s60, s60, 0x18000
    s_lshl_b32 s61, s49, 4
    s_add_u32 s61, s61, s60
    s_mov_b32 exec_lo, 0x20002
    s_mov_b32 exec_hi, 0x20002
    v_mov_b32 v12, v16
    v_mov_b32 v13, v17
    v_mov_b32 v14, v18
    v_mov_b32 v15, v19
    s_mov_b64 exec, -1
    v_add_u32 v12, 0x200, v12
    v_add_u32 v13, 0x200, v13
    v_add_u32 v14, 0x200, v14
    v_add_u32 v15, 0x200, v15
    v_bfi_b32 v12, v157, s52, v12
    v_bfi_b32 v13, v157, s67, v13
    v_bfi_b32 v14, v157, s52, v14
    v_bfi_b32 v15, v157, s67, v15
    s_mov_b64 exec, 4
    v_mov_b32 v12, s82
    v_mov_b32 v13, s52
    v_mov_b32 v14, s82
    v_mov_b32 v15, s52
    v_mov_b32 v144, s61
    s_mov_b32 exec_lo, 0x30007
    s_mov_b32 exec_hi, 0x30003
    buffer_store_dwordx4 v[12:15], v144, s[28:31], 0 offen
    s_mov_b64 exec, -1
    v_and_b32 v145, 0x1f0, v156
    s_mov_b32 s63, 24
L_qpoll:
    buffer_load_dwordx4 v[60:63], v156, s[28:31], s59 offen offset:0 sc1
    buffer_load_dwordx4 v[64:67], v156, s[28:31], s59 offen offset:1024 sc1
    buffer_load_dwordx4 v[68:71], v156, s[28:31], s59 offen offset:2048 sc1
    buffer_load_dwordx4 v[72:75], v156, s[28:31], s59 offen offset:3072 sc1
    buffer_load_dwordx4 v[76:79], v145, s[28:31], s60 offen sc1
    s_sub_u32 s53, s53, 1
    s_cbranch_scc1 L_end
    s_waitcnt vmcnt(0)
    v_xor_b32 v60, s75, v60
    v_xor_b32 v61, s67, v61
    v_xor_b32 v62, s75, v62
    v_xor_b32 v63, s67, v63
    v_xor_b32 v64, s75, v64
    v_xor_b32 v65, s67, v65
    v_xor_b32 v66, s75, v66
    v_xor_b32 v67, s67, v67
    v_xor_b32 v68, s75, v68
    v_xor_b32 v69, s67, v69
    v_xor_b32 v70, s75, v70
    v_xor_b32 v71, s67, v71
    v_xor_b32 v72, s75, v72
    v_xor_b32 v73, s67, v73
    v_xor_b32 v74, s75, v74
    v_xor_b32 v75, s67, v75
    v_or3_b32 v20, v60, v61, v62
    v_or3_b32 v20, v20, v63, v64
    v_or3_b32 v20, v20, v65, v66
    v_or3_b32 v20, v20, v67, v68
    v_or3_b32 v20, v20, v69, v70
    v_or3_b32 v20, v20, v71, v72
    v_or3_b32 v20, v20, v73, v74
    v_bitop3_b32 v20, v20, v75, v157 bitop3:0xa8
    v_bitop3_b32 v20, v77, s52, v20 bitop3:0xbe
    v_bitop3_b32 v20, v79, s52, v20 bitop3:0xbe
    v_cmp_ne_u32 vcc, 0, v20
    s_nop 0
    s_cbranch_vccz L_qok
    s_sub_u32 s63, s63, 1
    s_cmp_eq_u32 s63, 0
    s_cbranch_scc0 L_qpoll
    s_mov_b32 exec_lo, 0x30007
    s_mov_b32 exec_hi, 0x30003
    buffer_store_dwordx4 v[12:15], v144, s[28:31], 0 offen sc1
    s_mov_b64 exec, -1
    s_branch L_qpoll
L_qok:
    v_add_f32 v60, v60, v68
    v_add_f32 v61, v61, v69
    v_add_f32 v62, v62, v70
    v_add_f32 v63, v63, v71
    v_add_f32 v64, v64, v72
    v_add_f32 v65, v65, v73
    v_add_f32 v66, v66, v74
    v_add_f32 v67, v67, v75
    v_cvt_pk_bf16_f32 v60, v60, v61
    v_cvt_pk_bf16_f32 v61, v62, v63
    v_cvt_pk_bf16_f32 v62, v64, v65
    v_cvt_pk_bf16_f32 v63, v66, v67
    v_lshlrev_b32 v145, 3, v0
    v_add_u32 v145, 143360, v145
    ds_write2st64_b64 v145, v[60:61], v[62:63] offset0:0 offset1:1
    v_cmp_ne_u32 vcc, s82, v76
    s_mov_b32 s78, 1
    s_cmp_eq_u64 vcc, 0
    s_cselect_b32 s78, 2, 1
    v_mov_b32 v20, s78
    ds_write_b32 v4, v20 offset:8
    s_cmp_eq_u32 s78, 2
    s_cbranch_scc1 L_qnorep
    s_mov_b32 exec_lo, 0x30007
    s_mov_b32 exec_hi, 0x30003
    buffer_store_dwordx4 v[12:15], v144, s[28:31], 0 offen sc1
    s_mov_b64 exec, -1
L_qnorep:
L_qready:
    v_lshlrev_b32 v144, 8, v11
    v_lshl_add_u32 v144, v2, 4, v144
    v_add_u32 v144, 143360, v144
    ds_read_b128 v[12:15], v144 offset:0
    ds_read_b128 v[16:19], v144 offset:64
    ds_read_b128 v[20:23], v144 offset:128
    ds_read_b128 v[24:27], v144 offset:192
    v_mov_b32 v28, 0
    v_mov_b32 v29, 0
    v_mov_b32 v30, 0
    v_mov_b32 v31, 0
    v_mov_b32 v32, 0
    v_mov_b32 v33, 0
    v_mov_b32 v34, 0
    v_mov_b32 v35, 0
    v_mov_b32 v8, 0xff800000
    v_mov_b32 v10, 0
    s_mov_b32 s63, 16
    s_lshl_b32 s56, s55, 13
    s_mov_b32 s84, 0x000f000f
    s_mov_b32 s85, 0x000f000f
    v_lshlrev_b32 v180, 4, v11
    v_lshl_add_u32 v177, v2, 6, v180
    v_add_u32 v177, 144384, v177
    s_lshl_b32 s61, s69, 8
    v_add_u32 v176, s61, v177
    s_add_u32 s61, s61, 144384
    v_lshlrev_b32 v178, 4, v3
    v_lshl_add_u32 v178, v2, 10, v178
    v_add_u32 v178, s61, v178
    v_add_u32 v180, 139392, v180
    s_lshl_b32 s61, s69, 2
    v_add_u32 v179, s61, v180
    s_lshl_b32 s61, s69, 6
    v_xor_b32 v181, s61, v7
    v_xor_b32 v182, 32, v181
    s_lshl_b32 s61, s48, 16
    s_lshl_b32 s62, s49, 6
    s_add_u32 s61, s61, s62
    s_lshl_b32 s62, s69, 12
    s_add_u32 s61, s61, s62
    s_add_u32 s59, s61, 0x280000
    s_add_u32 s83, s59, 2048
    v_lshlrev_b32 v183, 14, v11
    v_lshl_add_u32 v183, v2, 4, v183
    v_lshlrev_b32 v184, 9, v11
    s_lshl_b32 s61, s48, 11
    s_lshl_b32 s62, s49, 4
    s_add_u32 s61, s61, s62
    s_add_u32 s60, s61, 0x58000
L_kstep:
    s_cmp_gt_i32 s54, s55
    s_cbranch_scc1 L_fok_53
L_fp_54:
    ds_read_b64 v[144:145], v4
    s_sub_u32 s53, s53, 1
    s_cbranch_scc1 L_end
    s_waitcnt lgkmcnt(0)
    v_readfirstlane_b32 s54, v144
    v_readfirstlane_b32 s68, v145
    s_cmp_gt_i32 s54, s55
    s_cbranch_scc0 L_fp_54
L_fok_53:
    v_add_u32 v152, s56, v6
    v_xor_b32 v153, 64, v152
    v_xor_b32 v154, 128, v152
    v_xor_b32 v155, 192, v152
    ds_read_b128 v[60:63], v152 offset:0
    ds_read_b128 v[64:67], v153 offset:0
    ds_read_b128 v[68:71], v154 offset:0
    ds_read_b128 v[72:75], v155 offset:0
    ds_read_b128 v[76:79], v152 offset:4096
    ds_read_b128 v[80:83], v153 offset:4096
    ds_read_b128 v[84:87], v154 offset:4096
    ds_read_b128 v[88:91], v155 offset:4096
    s_add_u32 s55, s55, 4
    s_min_u32 s55, s55, 68
    v_mov_b32 v144, s55
    s_waitcnt lgkmcnt(4)
    v_mfma_f32_16x16x32_bf16 v[124:127], v[60:63], v[12:15], 0
    v_mfma_f32_16x16x32_bf16 v[124:127], v[64:67], v[16:19], v[124:127]
    v_mfma_f32_16x16x32_bf16 v[124:127], v[68:71], v[20:23], v[124:127]
    v_mfma_f32_16x16x32_bf16 v[124:127], v[72:75], v[24:27], v[124:127]
    s_waitcnt lgkmcnt(0)
    ds_write_b32 v5, v144
    v_mfma_f32_16x16x32_bf16 v[128:131], v[76:79], v[12:15], 0
    v_mfma_f32_16x16x32_bf16 v[128:131], v[80:83], v[16:19], v[128:131]
    v_mfma_f32_16x16x32_bf16 v[128:131], v[84:87], v[20:23], v[128:131]
    v_mfma_f32_16x16x32_bf16 v[128:131], v[88:91], v[24:27], v[128:131]
    s_add_u32 s56, s56, 32768
    s_sub_u32 s61, s56, 139264
    s_cselect_b32 s56, s56, s61
    v_cvt_pk_bf16_f32 v140, v124, v125
    v_cvt_pk_bf16_f32 v141, v126, v127
    s_nop 2
    v_cvt_pk_bf16_f32 v142, v128, v129
    v_cvt_pk_bf16_f32 v143, v130, v131
    s_mov_b64 exec, s[84:85]
    ds_write_b128 v176, v[140:143]
    s_mov_b64 exec, -1
    v_add_u32 v176, 1024, v176
    v_max3_f32 v145, v124, v125, v126
    v_max3_f32 v146, v127, v128, v129
    v_max3_f32 v8, v130, v131, v8
    v_max3_f32 v8, v145, v146, v8
    s_sub_u32 s63, s63, 1
    s_cmp_lg_u32 s63, 0
    s_cbranch_scc1 L_kstep
    ds_read_b128 v[60:63], v178 offset:0
    ds_read_b128 v[64:67], v178 offset:4096
    ds_read_b128 v[68:71], v178 offset:8192
    ds_read_b128 v[72:75], v178 offset:12288
    v_mov_b32 v144, v8
    s_nop 1
    v_permlane16_swap_b32 v8, v144
    v_max_f32 v8, v8, v144
    v_mov_b32 v144, v8
    s_nop 1
    v_permlane32_swap_b32 v8, v144
    v_max_f32 v8, v8, v144
    v_mov_b32 v144, 1
    s_mov_b64 exec, 15
    ds_write_b32 v179, v8 offset:0
    ds_write_b32 v5, v144 offset:48
    s_mov_b64 exec, -1
    s_branch L_mr
L_mw:
    s_sub_u32 s53, s53, 1
    s_cbranch_scc1 L_end
    s_waitcnt lgkmcnt(0)
L_mr:
    ds_read_b128 v[164:167], v4 offset:64
    ds_read_b128 v[168:171], v180 offset:0
    s_waitcnt lgkmcnt(1)
    v_min3_u32 v164, v164, v165, v166
    v_min_u32 v164, v164, v167
    v_cmp_eq_u32 vcc, 0, v164
    s_nop 0
    s_cbranch_vccnz L_mw
    s_waitcnt lgkmcnt(0)
    v_max3_f32 v8, v168, v169, v170
    v_max_f32 v8, v8, v171
    v_cvt_pk_bf16_f32 v8, v8, v8
    v_and_b32 v8, 0xffff0000, v8
    v_mul_f32 v8, s65, v8
    v_cvt_pk_bf16_f32 v8, v8, v8
    v_and_b32 v8, 0xffff0000, v8
    v_mul_f32 v9, s66, v8
    v_lshlrev_b32 v92, 16, v60
    v_and_b32 v93, 0xffff0000, v60
    v_lshlrev_b32 v94, 16, v61
    v_and_b32 v95, 0xffff0000, v61
    v_lshlrev_b32 v96, 16, v62
    v_and_b32 v97, 0xffff0000, v62
    v_lshlrev_b32 v98, 16, v63
    v_and_b32 v99, 0xffff0000, v63
    v_mul_f32 v92, s65, v92
    v_mul_f32 v93, s65, v93
    v_mul_f32 v94, s65, v94
    v_mul_f32 v95, s65, v95
    v_mul_f32 v96, s65, v96
    v_mul_f32 v97, s65, v97
    v_mul_f32 v98, s65, v98
    v_mul_f32 v99, s65, v99
    v_cvt_pk_bf16_f32 v60, v92, v93
    v_cvt_pk_bf16_f32 v61, v94, v95
    v_cvt_pk_bf16_f32 v62, v96, v97
    v_cvt_pk_bf16_f32 v63, v98, v99
    v_lshlrev_b32 v92, 16, v60
    v_and_b32 v93, 0xffff0000, v60
    v_lshlrev_b32 v94, 16, v61
    v_and_b32 v95, 0xffff0000, v61
    v_lshlrev_b32 v96, 16, v62
    v_and_b32 v97, 0xffff0000, v62
    v_lshlrev_b32 v98, 16, v63
    v_and_b32 v99, 0xffff0000, v63
    v_fma_f32 v92, v92, s66, -v9
    v_fma_f32 v93, v93, s66, -v9
    v_fma_f32 v94, v94, s66, -v9
    v_fma_f32 v95, v95, s66, -v9
    v_fma_f32 v96, v96, s66, -v9
    v_fma_f32 v97, v97, s66, -v9
    v_fma_f32 v98, v98, s66, -v9
    v_fma_f32 v99, v99, s66, -v9
    v_exp_f32 v92, v92
    v_exp_f32 v93, v93
    v_exp_f32 v94, v94
    v_exp_f32 v95, v95
    v_exp_f32 v96, v96
    v_exp_f32 v97, v97
    v_exp_f32 v98, v98
    v_exp_f32 v99, v99
    v_cvt_pk_bf16_f32 v60, v92, v93
    v_cvt_pk_bf16_f32 v61, v94, v95
    v_cvt_pk_bf16_f32 v62, v96, v97
    v_cvt_pk_bf16_f32 v63, v98, v99
    ds_write_b128 v178, v[60:63] offset:0
    v_add_f32 v92, v92, v96
    v_add_f32 v93, v93, v97
    v_add_f32 v94, v94, v98
    v_add_f32 v95, v95, v99
    v_add_f32 v92, v92, v94
    v_add_f32 v93, v93, v95
    v_add_f32 v92, v92, v93
    v_add_f32 v10, v10, v92
    v_lshlrev_b32 v100, 16, v64
    v_and_b32 v101, 0xffff0000, v64
    v_lshlrev_b32 v102, 16, v65
    v_and_b32 v103, 0xffff0000, v65
    v_lshlrev_b32 v104, 16, v66
    v_and_b32 v105, 0xffff0000, v66
    v_lshlrev_b32 v106, 16, v67
    v_and_b32 v107, 0xffff0000, v67
    v_mul_f32 v100, s65, v100
    v_mul_f32 v101, s65, v101
    v_mul_f32 v102, s65, v102
    v_mul_f32 v103, s65, v103
    v_mul_f32 v104, s65, v104
    v_mul_f32 v105, s65, v105
    v_mul_f32 v106, s65, v106
    v_mul_f32 v107, s65, v107
    v_cvt_pk_bf16_f32 v64, v100, v101
    v_cvt_pk_bf16_f32 v65, v102, v103
    v_cvt_pk_bf16_f32 v66, v104, v105
    v_cvt_pk_bf16_f32 v67, v106, v107
    v_lshlrev_b32 v100, 16, v64
    v_and_b32 v101, 0xffff0000, v64
    v_lshlrev_b32 v102, 16, v65
    v_and_b32 v103, 0xffff0000, v65
    v_lshlrev_b32 v104, 16, v66
    v_and_b32 v105, 0xffff0000, v66
    v_lshlrev_b32 v106, 16, v67
    v_and_b32 v107, 0xffff0000, v67
    v_fma_f32 v100, v100, s66, -v9
    v_fma_f32 v101, v101, s66, -v9
    v_fma_f32 v102, v102, s66, -v9
    v_fma_f32 v103, v103, s66, -v9
    v_fma_f32 v104, v104, s66, -v9
    v_fma_f32 v105, v105, s66, -v9
    v_fma_f32 v106, v106, s66, -v9
    v_fma_f32 v107, v107, s66, -v9
    v_exp_f32 v100, v100
    v_exp_f32 v101, v101
    v_exp_f32 v102, v102
    v_exp_f32 v103, v103
    v_exp_f32 v104, v104
    v_exp_f32 v105, v105
    v_exp_f32 v106, v106
    v_exp_f32 v107, v107
    v_cvt_pk_bf16_f32 v64, v100, v101
    v_cvt_pk_bf16_f32 v65, v102, v103
    v_cvt_pk_bf16_f32 v66, v104, v105
    v_cvt_pk_bf16_f32 v67, v106, v107
    ds_write_b128 v178, v[64:67] offset:4096
    v_add_f32 v100, v100, v104
    v_add_f32 v101, v101, v105
    v_add_f32 v102, v102, v106
    v_add_f32 v103, v103, v107
    v_add_f32 v100, v100, v102
    v_add_f32 v101, v101, v103
    v_add_f32 v100, v100, v101
    v_add_f32 v10, v10, v100
    v_lshlrev_b32 v108, 16, v68
    v_and_b32 v109, 0xffff0000, v68
    v_lshlrev_b32 v110, 16, v69
    v_and_b32 v111, 0xffff0000, v69
    v_lshlrev_b32 v112, 16, v70
    v_and_b32 v113, 0xffff0000, v70
    v_lshlrev_b32 v114, 16, v71
    v_and_b32 v115, 0xffff0000, v71
    v_mul_f32 v108, s65, v108
    v_mul_f32 v109, s65, v109
    v_mul_f32 v110, s65, v110
    v_mul_f32 v111, s65, v111
    v_mul_f32 v112, s65, v112
    v_mul_f32 v113, s65, v113
    v_mul_f32 v114, s65, v114
    v_mul_f32 v115, s65, v115
    v_cvt_pk_bf16_f32 v68, v108, v109
    v_cvt_pk_bf16_f32 v69, v110, v111
    v_cvt_pk_bf16_f32 v70, v112, v113
    v_cvt_pk_bf16_f32 v71, v114, v115
    v_lshlrev_b32 v108, 16, v68
    v_and_b32 v109, 0xffff0000, v68
    v_lshlrev_b32 v110, 16, v69
    v_and_b32 v111, 0xffff0000, v69
    v_lshlrev_b32 v112, 16, v70
    v_and_b32 v113, 0xffff0000, v70
    v_lshlrev_b32 v114, 16, v71
    v_and_b32 v115, 0xffff0000, v71
    v_fma_f32 v108, v108, s66, -v9
    v_fma_f32 v109, v109, s66, -v9
    v_fma_f32 v110, v110, s66, -v9
    v_fma_f32 v111, v111, s66, -v9
    v_fma_f32 v112, v112, s66, -v9
    v_fma_f32 v113, v113, s66, -v9
    v_fma_f32 v114, v114, s66, -v9
    v_fma_f32 v115, v115, s66, -v9
    v_exp_f32 v108, v108
    v_exp_f32 v109, v109
    v_exp_f32 v110, v110
    v_exp_f32 v111, v111
    v_exp_f32 v112, v112
    v_exp_f32 v113, v113
    v_exp_f32 v114, v114
    v_exp_f32 v115, v115
    v_cvt_pk_bf16_f32 v68, v108, v109
    v_cvt_pk_bf16_f32 v69, v110, v111
    v_cvt_pk_bf16_f32 v70, v112, v113
    v_cvt_pk_bf16_f32 v71, v114, v115
    ds_write_b128 v178, v[68:71] offset:8192
    v_add_f32 v108, v108, v112
    v_add_f32 v109, v109, v113
    v_add_f32 v110, v110, v114
    v_add_f32 v111, v111, v115
    v_add_f32 v108, v108, v110
    v_add_f32 v109, v109, v111
    v_add_f32 v108, v108, v109
    v_add_f32 v10, v10, v108
    v_lshlrev_b32 v116, 16, v72
    v_and_b32 v117, 0xffff0000, v72
    v_lshlrev_b32 v118, 16, v73
    v_and_b32 v119, 0xffff0000, v73
    v_lshlrev_b32 v120, 16, v74
    v_and_b32 v121, 0xffff0000, v74
    v_lshlrev_b32 v122, 16, v75
    v_and_b32 v123, 0xffff0000, v75
    v_mul_f32 v116, s65, v116
    v_mul_f32 v117, s65, v117
    v_mul_f32 v118, s65, v118
    v_mul_f32 v119, s65, v119
    v_mul_f32 v120, s65, v120
    v_mul_f32 v121, s65, v121
    v_mul_f32 v122, s65, v122
    v_mul_f32 v123, s65, v123
    v_cvt_pk_bf16_f32 v72, v116, v117
    v_cvt_pk_bf16_f32 v73, v118, v119
    v_cvt_pk_bf16_f32 v74, v120, v121
    v_cvt_pk_bf16_f32 v75, v122, v123
    v_lshlrev_b32 v116, 16, v72
    v_and_b32 v117, 0xffff0000, v72
    v_lshlrev_b32 v118, 16, v73
    v_and_b32 v119, 0xffff0000, v73
    v_lshlrev_b32 v120, 16, v74
    v_and_b32 v121, 0xffff0000, v74
    v_lshlrev_b32 v122, 16, v75
    v_and_b32 v123, 0xffff0000, v75
    v_fma_f32 v116, v116, s66, -v9
    v_fma_f32 v117, v117, s66, -v9
    v_fma_f32 v118, v118, s66, -v9
    v_fma_f32 v119, v119, s66, -v9
    v_fma_f32 v120, v120, s66, -v9
    v_fma_f32 v121, v121, s66, -v9
    v_fma_f32 v122, v122, s66, -v9
    v_fma_f32 v123, v123, s66, -v9
    v_exp_f32 v116, v116
    v_exp_f32 v117, v117
    v_exp_f32 v118, v118
    v_exp_f32 v119, v119
    v_exp_f32 v120, v120
    v_exp_f32 v121, v121
    v_exp_f32 v122, v122
    v_exp_f32 v123, v123
    v_cvt_pk_bf16_f32 v72, v116, v117
    v_cvt_pk_bf16_f32 v73, v118, v119
    v_cvt_pk_bf16_f32 v74, v120, v121
    v_cvt_pk_bf16_f32 v75, v122, v123
    ds_write_b128 v178, v[72:75] offset:12288
    v_add_f32 v116, v116, v120
    v_add_f32 v117, v117, v121
    v_add_f32 v118, v118, v122
    v_add_f32 v119, v119, v123
    v_add_f32 v116, v116, v118
    v_add_f32 v117, v117, v119
    v_add_f32 v116, v116, v117
    v_add_f32 v10, v10, v116
    s_nop 1
    v_add_f32_dpp v10, v10, v10 row_ror:4 row_mask:0xf bank_mask:0xf
    s_nop 1
    v_add_f32_dpp v10, v10, v10 row_ror:8 row_mask:0xf bank_mask:0xf
    v_mov_b32 v144, v10
    s_nop 1
    v_permlane16_swap_b32 v10, v144
    v_add_f32 v10, v10, v144
    v_mov_b32 v144, v10
    s_nop 1
    v_permlane32_swap_b32 v10, v144
    v_add_f32 v10, v10, v144
    v_mov_b32 v144, 1
    s_mov_b64 exec, 15
    ds_write_b32 v179, v10 offset:64
    ds_write_b32 v5, v144 offset:80
    s_mov_b64 exec, -1
    s_branch L_lr
L_lw:
    s_sub_u32 s53, s53, 1
    s_cbranch_scc1 L_end
    s_waitcnt lgkmcnt(0)
L_lr:
    ds_read_b128 v[164:167], v4 offset:96
    ds_read_b128 v[168:171], v180 offset:64
    s_waitcnt lgkmcnt(1)
    v_min3_u32 v164, v164, v165, v166
    v_min_u32 v164, v164, v167
    v_cmp_eq_u32 vcc, 0, v164
    s_nop 0
    s_cbranch_vccnz L_lw
    s_waitcnt lgkmcnt(0)
    s_cmp_eq_u32 s69, 0
    s_cbranch_scc0 L_noml
    v_add_f32 v168, v168, v169
    v_add_f32 v170, v170, v171
    v_add_f32 v170, v168, v170
    v_mov_b32 v168, v8
    v_add_u32 v168, 0x200, v168
    v_add_u32 v169, 0x200, v169
    v_add_u32 v170, 0x200, v170
    v_add_u32 v171, 0x200, v171
    v_bfi_b32 v168, v157, s52, v168
    v_bfi_b32 v169, v157, s67, v169
    v_bfi_b32 v170, v157, s52, v170
    v_bfi_b32 v171, v157, s67, v171
    s_mov_b64 exec, 15
    s_cmp_eq_u32 s78, 2
    s_cbranch_scc1 L_sl_55
    buffer_store_dwordx4 v[168:171], v184, s[28:31], s60 offen sc1
    s_branch L_sd_56
L_sl_55:
    buffer_store_dwordx4 v[168:171], v184, s[28:31], s60 offen
L_sd_56:
    s_mov_b64 exec, -1
L_noml:
    s_mov_b32 s56, 0
    s_and_b32 s61, s49, 28
    s_add_u32 s61, s61, s69
    s_lshl_b32 s62, s48, 5
    s_add_u32 s61, s61, s62
    s_lshl_b32 s58, s61, 11
    s_add_u32 s58, s58, 0x280000
    s_lshl_b32 s61, s61, 14
    s_and_b32 s62, s49, 3
    s_lshl_b32 s62, s62, 8
    s_add_u32 s79, s61, s62
    v_lshlrev_b32 v185, 2, v0
    v_lshlrev_b32 v186, 3, v0
    s_lshl_b32 s61, s69, 9
    s_add_u32 s61, s61, 141312
    v_add_u32 v187, s61, v186
    v_add_u32 v186, 140288, v186
    v_mov_b32 v44, 0
    v_mov_b32 v45, 0
    v_mov_b32 v46, 0
    v_mov_b32 v47, 0
    s_mov_b64 s[86:87], -1
    s_mov_b64 s[88:89], -1
    v_bfe_u32 v144, v0, 2, 2
    v_xor_b32 v145, v2, v144
    v_lshlrev_b32 v145, 5, v145
    v_lshl_add_u32 v145, v144, 8, v145
    v_lshl_add_u32 v145, v11, 3, v145
    s_lshl_b32 s61, s69, 12
    s_add_u32 s61, s61, 106496
    v_add_u32 v188, s61, v145
    s_lshr_b32 s79, s69, 1
    s_add_u32 s79, s79, 132
    s_lshl_b32 s61, s69, 9
    s_add_u32 s61, s61, 141312
    v_add_u32 v187, s61, v185
L_vstep128:
    v_add_u32 v148, s56, v181
    v_add_u32 v149, s56, v182
    ds_read_b128 v[140:143], v177
    s_cmp_gt_i32 s54, s55
    s_cbranch_scc1 L_fok_57
L_fp_58:
    ds_read_b64 v[144:145], v4
    s_sub_u32 s53, s53, 1
    s_cbranch_scc1 L_end
    s_waitcnt lgkmcnt(0)
    v_readfirstlane_b32 s54, v144
    v_readfirstlane_b32 s68, v145
    s_cmp_gt_i32 s54, s55
    s_cbranch_scc0 L_fp_58
L_fok_57:
    ds_read_b64_tr_b16 v[92:93], v148
    ds_read_b64_tr_b16 v[94:95], v148 offset:4096
    ds_read_b64_tr_b16 v[96:97], v149
    ds_read_b64_tr_b16 v[98:99], v149 offset:4096
    s_add_u32 s55, s55, 1
    v_mov_b32 v144, s55
    v_add_u32 v177, 256, v177
    s_add_u32 s56, s56, 8192
    s_sub_u32 s61, s56, 139264
    s_cselect_b32 s56, s56, s61
    s_waitcnt lgkmcnt(2)
    v_mfma_f32_16x16x32_bf16 v[28:31], v[92:95], v[140:143], v[28:31]
    s_waitcnt lgkmcnt(0)
    ds_write_b32 v5, v144
    v_mfma_f32_16x16x32_bf16 v[32:35], v[96:99], v[140:143], v[32:35]
    s_cmp_lt_u32 s55, 128
    s_cbranch_scc1 L_vstep128
L_pww:
    ds_read_b32 v144, v4 offset:80
    ds_read_b64 v[140:141], v186
    s_sub_u32 s53, s53, 1
    s_cbranch_scc1 L_end
    s_waitcnt lgkmcnt(0)
    v_cmp_eq_u32 vcc, 0, v144
    s_nop 0
    s_cbranch_vccnz L_pww
    ds_read_b128 v[60:63], v177 offset:0
    ds_read_b128 v[64:67], v177 offset:256
    ds_read_b128 v[68:71], v177 offset:512
    ds_read_b128 v[72:75], v177 offset:768
    v_add_u32 v148, 73728, v181
    v_add_u32 v149, 73728, v182
    v_add_u32 v150, 81920, v181
    v_add_u32 v151, 81920, v182
    v_add_u32 v152, 90112, v181
    v_add_u32 v153, 90112, v182
    v_add_u32 v154, 98304, v181
    v_add_u32 v155, 98304, v182
    s_branch L_vr_60
L_vw_59:
    s_sub_u32 s53, s53, 1
    s_cbranch_scc1 L_end
    s_waitcnt lgkmcnt(0)
L_vr_60:
    ds_read_b32 v144, v4
    ds_read_b64_tr_b16 v[92:93], v148
    ds_read_b64_tr_b16 v[94:95], v148 offset:4096
    ds_read_b64_tr_b16 v[96:97], v149
    ds_read_b64_tr_b16 v[98:99], v149 offset:4096
    s_waitcnt lgkmcnt(4)
    v_cmp_ge_i32 vcc, 128, v144
    s_nop 0
    s_cbranch_vccnz L_vw_59
    s_waitcnt lgkmcnt(2)
    v_mfma_f32_16x16x32_bf16 v[28:31], v[92:95], v[60:63], v[28:31]
    s_waitcnt lgkmcnt(0)
    v_mfma_f32_16x16x32_bf16 v[32:35], v[96:99], v[60:63], v[32:35]
    s_branch L_vr_62
L_vw_61:
    s_sub_u32 s53, s53, 1
    s_cbranch_scc1 L_end
    s_waitcnt lgkmcnt(0)
L_vr_62:
    ds_read_b32 v144, v4
    ds_read_b64_tr_b16 v[100:101], v150
    ds_read_b64_tr_b16 v[102:103], v150 offset:4096
    ds_read_b64_tr_b16 v[104:105], v151
    ds_read_b64_tr_b16 v[106:107], v151 offset:4096
    s_waitcnt lgkmcnt(4)
    v_cmp_ge_i32 vcc, 129, v144
    s_nop 0
    s_cbranch_vccnz L_vw_61
    s_waitcnt lgkmcnt(2)
    v_mfma_f32_16x16x32_bf16 v[28:31], v[100:103], v[64:67], v[28:31]
    s_waitcnt lgkmcnt(0)
    v_mfma_f32_16x16x32_bf16 v[32:35], v[104:107], v[64:67], v[32:35]
    s_branch L_vr_64
L_vw_63:
    s_sub_u32 s53, s53, 1
    s_cbranch_scc1 L_end
    s_waitcnt lgkmcnt(0)
L_vr_64:
    ds_read_b32 v144, v4
    ds_read_b64_tr_b16 v[108:109], v152
    ds_read_b64_tr_b16 v[110:111], v152 offset:4096
    ds_read_b64_tr_b16 v[112:113], v153
    ds_read_b64_tr_b16 v[114:115], v153 offset:4096
    s_waitcnt lgkmcnt(4)
    v_cmp_ge_i32 vcc, 130, v144
    s_nop 0
    s_cbranch_vccnz L_vw_63
    s_waitcnt lgkmcnt(2)
    v_mfma_f32_16x16x32_bf16 v[28:31], v[108:111], v[68:71], v[28:31]
    s_waitcnt lgkmcnt(0)
    v_mfma_f32_16x16x32_bf16 v[32:35], v[112:115], v[68:71], v[32:35]
    s_branch L_vr_66
L_vw_65:
    s_sub_u32 s53, s53, 1
    s_cbranch_scc1 L_end
    s_waitcnt lgkmcnt(0)
L_vr_66:
    ds_read_b32 v144, v4
    ds_read_b64_tr_b16 v[116:117], v154
    ds_read_b64_tr_b16 v[118:119], v154 offset:4096
    ds_read_b64_tr_b16 v[120:121], v155
    ds_read_b64_tr_b16 v[122:123], v155 offset:4096
    s_waitcnt lgkmcnt(4)
    v_cmp_ge_i32 vcc, 131, v144
    s_nop 0
    s_cbranch_vccnz L_vw_65
    s_waitcnt lgkmcnt(2)
    v_mfma_f32_16x16x32_bf16 v[28:31], v[116:119], v[72:75], v[28:31]
    s_waitcnt lgkmcnt(0)
    v_mfma_f32_16x16x32_bf16 v[32:35], v[120:123], v[72:75], v[32:35]
    s_cmp_eq_u32 s78, 2
    s_cbranch_scc0 L_outg
    s_mov_b64 exec, s[84:85]
    s_nop 2
    v_add_u32 v28, 0x200, v28
    v_add_u32 v29, 0x200, v29
    v_add_u32 v30, 0x200, v30
    v_add_u32 v31, 0x200, v31
    v_bfi_b32 v28, v157, s52, v28
    v_bfi_b32 v29, v157, s67, v29
    v_bfi_b32 v30, v157, s52, v30
    v_bfi_b32 v31, v157, s67, v31
    buffer_store_dwordx4 v[28:31], v183, s[28:31], s59 offen
    v_add_u32 v32, 0x200, v32
    v_add_u32 v33, 0x200, v33
    v_add_u32 v34, 0x200, v34
    v_add_u32 v35, 0x200, v35
    v_bfi_b32 v32, v157, s52, v32
    v_bfi_b32 v33, v157, s67, v33
    v_bfi_b32 v34, v157, s52, v34
    v_bfi_b32 v35, v157, s67, v35
    buffer_store_dwordx4 v[32:35], v183, s[28:31], s83 offen
    s_branch L_outd
L_outg:
    s_mov_b64 exec, s[84:85]
    s_nop 2
    v_add_u32 v28, 0x200, v28
    v_add_u32 v29, 0x200, v29
    v_add_u32 v30, 0x200, v30
    v_add_u32 v31, 0x200, v31
    v_bfi_b32 v28, v157, s52, v28
    v_bfi_b32 v29, v157, s67, v29
    v_bfi_b32 v30, v157, s52, v30
    v_bfi_b32 v31, v157, s67, v31
    buffer_store_dwordx4 v[28:31], v183, s[28:31], s59 offen sc1
    v_add_u32 v32, 0x200, v32
    v_add_u32 v33, 0x200, v33
    v_add_u32 v34, 0x200, v34
    v_add_u32 v35, 0x200, v35
    v_bfi_b32 v32, v157, s52, v32
    v_bfi_b32 v33, v157, s67, v33
    v_bfi_b32 v34, v157, s52, v34
    v_bfi_b32 v35, v157, s67, v35
    buffer_store_dwordx4 v[32:35], v183, s[28:31], s83 offen sc1
L_outd:
    s_mov_b64 exec, -1
    s_waitcnt vmcnt(0)
    buffer_load_dwordx4 v[92:95], v156, s[28:31], s58 offen offset:0 sc1
    buffer_load_dwordx4 v[96:99], v156, s[28:31], s58 offen offset:1024 sc1
    ds_read_b32 v145, v4
    ds_read_b64_tr_b16 v[192:193], v188 offset:0
    ds_read_b64_tr_b16 v[194:195], v188 offset:128
    ds_read_b64_tr_b16 v[196:197], v188 offset:1152
    ds_read_b64_tr_b16 v[198:199], v188 offset:1024
    ds_read_b64_tr_b16 v[200:201], v188 offset:2048
    ds_read_b64_tr_b16 v[202:203], v188 offset:2176
    ds_read_b64_tr_b16 v[204:205], v188 offset:3200
    ds_read_b64_tr_b16 v[206:207], v188 offset:3072
    s_branch L_cchk
L_cpoll:
    s_mov_b64 exec, s[86:87]
    s_cbranch_execz L_mz_67
    buffer_load_dwordx4 v[92:95], v156, s[28:31], s58 offen offset:0 sc1
L_mz_67:
    s_mov_b64 exec, s[88:89]
    s_cbranch_execz L_mz_68
    buffer_load_dwordx4 v[96:99], v156, s[28:31], s58 offen offset:1024 sc1
L_mz_68:
    s_mov_b64 exec, -1
    ds_read_b32 v145, v4
    ds_read_b64_tr_b16 v[192:193], v188 offset:0
    ds_read_b64_tr_b16 v[194:195], v188 offset:128
    ds_read_b64_tr_b16 v[196:197], v188 offset:1152
    ds_read_b64_tr_b16 v[198:199], v188 offset:1024
    ds_read_b64_tr_b16 v[200:201], v188 offset:2048
    ds_read_b64_tr_b16 v[202:203], v188 offset:2176
    ds_read_b64_tr_b16 v[204:205], v188 offset:3200
    ds_read_b64_tr_b16 v[206:207], v188 offset:3072
    s_sub_u32 s53, s53, 1
    s_cbranch_scc1 L_end
L_cchk:
    s_waitcnt vmcnt(0)
    s_cmp_eq_u64 s[86:87], 0
    s_cbranch_scc1 L_rc_69
    v_xor_b32 v76, s75, v92
    v_xor_b32 v77, s67, v93
    v_xor_b32 v78, s75, v94
    v_xor_b32 v79, s67, v95
    v_or3_b32 v144, v76, v77, v78
    v_bitop3_b32 v144, v144, v79, v157 bitop3:0xa8
    v_cmp_ne_u32 vcc, 0, v144
    s_nop 0
    s_mov_b64 s[86:87], vcc
L_rc_69:
    s_cmp_eq_u64 s[88:89], 0
    s_cbranch_scc1 L_rc_70
    v_xor_b32 v80, s75, v96
    v_xor_b32 v81, s67, v97
    v_xor_b32 v82, s75, v98
    v_xor_b32 v83, s67, v99
    v_or3_b32 v144, v80, v81, v82
    v_bitop3_b32 v144, v144, v83, v157 bitop3:0xa8
    v_cmp_ne_u32 vcc, 0, v144
    s_nop 0
    s_mov_b64 s[88:89], vcc
L_rc_70:
    s_or_b64 vcc, s[86:87], s[88:89]
    s_cbranch_scc1 L_cpoll
    v_pk_mul_f32 v[124:125], v[76:77], v[140:141] op_sel_hi:[1,0]
    v_pk_mul_f32 v[126:127], v[78:79], v[140:141] op_sel_hi:[1,0]
    v_pk_fma_f32 v[124:125], v[80:81], v[140:141], v[124:125] op_sel:[0,1,0] op_sel_hi:[1,1,1]
    v_pk_fma_f32 v[126:127], v[82:83], v[140:141], v[126:127] op_sel:[0,1,0] op_sel_hi:[1,1,1]
    s_nop 0
    v_permlane16_swap_b32 v124, v125
    v_permlane16_swap_b32 v126, v127
    v_add_f32 v124, v124, v125
    v_add_f32 v126, v126, v127
    s_nop 1
    v_permlane32_swap_b32 v124, v126
    v_add_f32 v124, v124, v126
    s_nop 1
    v_add_f32_dpp v124, v124, v124 row_ror:4 row_mask:0xf bank_mask:0xf
    s_nop 1
    v_add_f32_dpp v124, v124, v124 row_ror:8 row_mask:0xf bank_mask:0xf
    v_mov_b32 v125, v124
    s_nop 1
    v_permlane16_swap_b32 v124, v125
    v_cvt_pk_bf16_f32 v132, v124, v125
    v_cvt_pk_bf16_f32 v133, v124, v125
    s_nop 1
    v_permlane32_swap_b32 v132, v133
    s_waitcnt lgkmcnt(0)
    v_cmp_ge_i32 vcc, s79, v145
    s_nop 0
    s_cbranch_vccnz L_wlate
L_wok:
    v_dot2c_f32_bf16_dpp v44, v132, v192 quad_perm:[0,0,0,0] row_mask:0xf bank_mask:0xf
    v_dot2c_f32_bf16_dpp v45, v132, v194 quad_perm:[0,0,0,0] row_mask:0xf bank_mask:0xf
    v_dot2c_f32_bf16_dpp v46, v133, v193 quad_perm:[0,0,0,0] row_mask:0xf bank_mask:0xf
    v_dot2c_f32_bf16_dpp v47, v133, v195 quad_perm:[0,0,0,0] row_mask:0xf bank_mask:0xf
    v_dot2c_f32_bf16_dpp v44, v132, v196 quad_perm:[1,1,1,1] row_mask:0xf bank_mask:0xf
    v_dot2c_f32_bf16_dpp v45, v132, v198 quad_perm:[1,1,1,1] row_mask:0xf bank_mask:0xf
    v_dot2c_f32_bf16_dpp v46, v133, v197 quad_perm:[1,1,1,1] row_mask:0xf bank_mask:0xf
    v_dot2c_f32_bf16_dpp v47, v133, v199 quad_perm:[1,1,1,1] row_mask:0xf bank_mask:0xf
    v_dot2c_f32_bf16_dpp v44, v132, v200 quad_perm:[2,2,2,2] row_mask:0xf bank_mask:0xf
    v_dot2c_f32_bf16_dpp v45, v132, v202 quad_perm:[2,2,2,2] row_mask:0xf bank_mask:0xf
    v_dot2c_f32_bf16_dpp v46, v133, v201 quad_perm:[2,2,2,2] row_mask:0xf bank_mask:0xf
    v_dot2c_f32_bf16_dpp v47, v133, v203 quad_perm:[2,2,2,2] row_mask:0xf bank_mask:0xf
    v_dot2c_f32_bf16_dpp v44, v132, v204 quad_perm:[3,3,3,3] row_mask:0xf bank_mask:0xf
    v_dot2c_f32_bf16_dpp v45, v132, v206 quad_perm:[3,3,3,3] row_mask:0xf bank_mask:0xf
    v_dot2c_f32_bf16_dpp v46, v133, v205 quad_perm:[3,3,3,3] row_mask:0xf bank_mask:0xf
    v_dot2c_f32_bf16_dpp v47, v133, v207 quad_perm:[3,3,3,3] row_mask:0xf bank_mask:0xf
    s_nop 2
    v_pk_add_f32 v[44:45], v[44:45], v[46:47]
    ds_write2st64_b32 v187, v44, v45 offset0:0 offset1:1
    s_waitcnt lgkmcnt(0)
    s_barrier
    s_endpgm
L_wlate:
    ds_read_b32 v145, v4
    ds_read_b64_tr_b16 v[192:193], v188 offset:0
    ds_read_b64_tr_b16 v[194:195], v188 offset:128
    ds_read_b64_tr_b16 v[196:197], v188 offset:1152
    ds_read_b64_tr_b16 v[198:199], v188 offset:1024
    ds_read_b64_tr_b16 v[200:201], v188 offset:2048
    ds_read_b64_tr_b16 v[202:203], v188 offset:2176
    ds_read_b64_tr_b16 v[204:205], v188 offset:3200
    ds_read_b64_tr_b16 v[206:207], v188 offset:3072
    s_sub_u32 s53, s53, 1
    s_cbranch_scc1 L_end
    s_waitcnt lgkmcnt(0)
    v_cmp_ge_i32 vcc, s79, v145
    s_nop 0
    s_cbranch_vccnz L_wlate
    s_branch L_wok
L_help:
    s_lshl_b32 s61, s48, 16
    s_lshl_b32 s62, s49, 11
    s_add_u32 s61, s61, s62
    s_add_u32 s61, s61, 0x280000
    s_mov_b64 exec, 0xffff
    v_lshlrev_b32 v132, 7, v0
    buffer_load_dword v133, v132, s[28:31], s61 offen sc1
    s_mov_b64 exec, -1
    s_cmp_lt_u32 s51, 224
    s_cbranch_scc0 L_noffn
    s_and_b32 s62, s51, 7
    s_lshl_b32 s62, s62, 7
    s_add_u32 s61, s62, 142336
    v_lshl_add_u32 v72, v2, 3, s61
    ds_read2_b64 v[92:95], v72 offset0:0 offset1:4
    ds_read2_b64 v[96:99], v72 offset0:8 offset1:12
    v_lshlrev_b32 v148, 7, v1
    v_lshl_add_u32 v148, v11, 3, v148
    v_bfe_u32 v149, v1, 1, 2
    v_lshl_add_u32 v148, v149, 5, v148
    v_xor_b32 v149, 32, v148
    v_xor_b32 v150, 64, v148
    v_xor_b32 v151, 96, v148
    s_cmp_gt_i32 s54, 1
    s_cbranch_scc1 L_fok_71
L_fp_72:
    ds_read_b64 v[144:145], v4
    s_sub_u32 s53, s53, 1
    s_cbranch_scc1 L_end
    s_waitcnt lgkmcnt(0)
    v_readfirstlane_b32 s54, v144
    v_readfirstlane_b32 s68, v145
    s_cmp_gt_i32 s54, 1
    s_cbranch_scc0 L_fp_72
L_fok_71:
    s_lshl_b32 s61, s51, 13
    s_add_u32 s62, s61, 4096
    buffer_load_dwordx4 v[28:31], v156, s[36:39], s61 offen offset:0 nt
    buffer_load_dwordx4 v[32:35], v156, s[36:39], s61 offen offset:1024 nt
    buffer_load_dwordx4 v[36:39], v156, s[36:39], s61 offen offset:2048 nt
    buffer_load_dwordx4 v[40:43], v156, s[36:39], s61 offen offset:3072 nt
    buffer_load_dwordx4 v[44:47], v156, s[36:39], s62 offen offset:0 nt
    buffer_load_dwordx4 v[48:51], v156, s[36:39], s62 offen offset:1024 nt
    buffer_load_dwordx4 v[52:55], v156, s[36:39], s62 offen offset:2048 nt
    buffer_load_dwordx4 v[56:59], v156, s[36:39], s62 offen offset:3072 nt
    s_cmp_gt_i32 s54, 2
    s_cbranch_scc1 L_fok_73
L_fp_74:
    ds_read_b64 v[144:145], v4
    s_sub_u32 s53, s53, 1
    s_cbranch_scc1 L_end
    s_waitcnt lgkmcnt(0)
    v_readfirstlane_b32 s54, v144
    v_readfirstlane_b32 s68, v145
    s_cmp_gt_i32 s54, 2
    s_cbranch_scc0 L_fp_74
L_fok_73:
    ds_read_b64_tr_b16 v[60:61], v148 offset:16384
    ds_read_b64_tr_b16 v[62:63], v148 offset:18432
    ds_read_b64_tr_b16 v[64:65], v149 offset:16384
    ds_read_b64_tr_b16 v[66:67], v149 offset:18432
    ds_read_b64_tr_b16 v[68:69], v150 offset:16384
    ds_read_b64_tr_b16 v[70:71], v150 offset:18432
    ds_read_b64_tr_b16 v[72:73], v151 offset:16384
    ds_read_b64_tr_b16 v[74:75], v151 offset:18432
    ds_read_b64_tr_b16 v[76:77], v148 offset:20480
    ds_read_b64_tr_b16 v[78:79], v148 offset:22528
    ds_read_b64_tr_b16 v[80:81], v149 offset:20480
    ds_read_b64_tr_b16 v[82:83], v149 offset:22528
    s_waitcnt lgkmcnt(10)
    v_mfma_f32_16x16x32_bf16 v[160:163], v[60:63], v[92:95], 0
    ds_read_b64_tr_b16 v[84:85], v150 offset:20480
    ds_read_b64_tr_b16 v[86:87], v150 offset:22528
    s_waitcnt lgkmcnt(10)
    v_mfma_f32_16x16x32_bf16 v[164:167], v[64:67], v[92:95], 0
    ds_read_b64_tr_b16 v[88:89], v151 offset:20480
    ds_read_b64_tr_b16 v[90:91], v151 offset:22528
    s_waitcnt lgkmcnt(10)
    v_mfma_f32_16x16x32_bf16 v[168:171], v[68:71], v[92:95], 0
    s_waitcnt lgkmcnt(8)
    v_mfma_f32_16x16x32_bf16 v[172:175], v[72:75], v[92:95], 0
    s_waitcnt lgkmcnt(6)
    v_mfma_f32_16x16x32_bf16 v[160:163], v[76:79], v[96:99], v[160:163]
    s_waitcnt lgkmcnt(4)
    v_mfma_f32_16x16x32_bf16 v[164:167], v[80:83], v[96:99], v[164:167]
    s_waitcnt lgkmcnt(2)
    v_mfma_f32_16x16x32_bf16 v[168:171], v[84:87], v[96:99], v[168:171]
    s_waitcnt lgkmcnt(0)
    v_mfma_f32_16x16x32_bf16 v[172:175], v[88:91], v[96:99], v[172:175]
    s_cmp_gt_i32 s54, 3
    s_cbranch_scc1 L_fok_75
L_fp_76:
    ds_read_b64 v[144:145], v4
    s_sub_u32 s53, s53, 1
    s_cbranch_scc1 L_end
    s_waitcnt lgkmcnt(0)
    v_readfirstlane_b32 s54, v144
    v_readfirstlane_b32 s68, v145
    s_cmp_gt_i32 s54, 3
    s_cbranch_scc0 L_fp_76
L_fok_75:
    ds_read_b64_tr_b16 v[60:61], v148 offset:24576
    ds_read_b64_tr_b16 v[62:63], v148 offset:26624
    ds_read_b64_tr_b16 v[64:65], v149 offset:24576
    ds_read_b64_tr_b16 v[66:67], v149 offset:26624
    ds_read_b64_tr_b16 v[68:69], v150 offset:24576
    ds_read_b64_tr_b16 v[70:71], v150 offset:26624
    ds_read_b64_tr_b16 v[72:73], v151 offset:24576
    ds_read_b64_tr_b16 v[74:75], v151 offset:26624
    ds_read_b64_tr_b16 v[76:77], v148 offset:28672
    ds_read_b64_tr_b16 v[78:79], v148 offset:30720
    ds_read_b64_tr_b16 v[80:81], v149 offset:28672
    ds_read_b64_tr_b16 v[82:83], v149 offset:30720
    s_waitcnt lgkmcnt(10)
    v_mfma_f32_16x16x32_bf16 v[176:179], v[60:63], v[92:95], 0
    ds_read_b64_tr_b16 v[84:85], v150 offset:28672
    ds_read_b64_tr_b16 v[86:87], v150 offset:30720
    s_waitcnt lgkmcnt(10)
    v_mfma_f32_16x16x32_bf16 v[180:183], v[64:67], v[92:95], 0
    ds_read_b64_tr_b16 v[88:89], v151 offset:28672
    ds_read_b64_tr_b16 v[90:91], v151 offset:30720
    s_waitcnt lgkmcnt(10)
    v_mfma_f32_16x16x32_bf16 v[184:187], v[68:71], v[92:95], 0
    s_waitcnt lgkmcnt(8)
    v_mfma_f32_16x16x32_bf16 v[188:191], v[72:75], v[92:95], 0
    s_waitcnt lgkmcnt(6)
    v_mfma_f32_16x16x32_bf16 v[176:179], v[76:79], v[96:99], v[176:179]
    s_waitcnt lgkmcnt(4)
    v_mfma_f32_16x16x32_bf16 v[180:183], v[80:83], v[96:99], v[180:183]
    s_waitcnt lgkmcnt(2)
    v_mfma_f32_16x16x32_bf16 v[184:187], v[84:87], v[96:99], v[184:187]
    s_waitcnt lgkmcnt(0)
    v_mfma_f32_16x16x32_bf16 v[188:191], v[88:91], v[96:99], v[188:191]
    v_mov_b32 v20, 0x7fffffff
    ds_write_b32 v5, v20
    s_mov_b32 exec_lo, 0x20002
    s_mov_b32 exec_hi, 0x20002
    v_mov_b32 v160, v164
    v_mov_b32 v161, v165
    v_mov_b32 v162, v166
    v_mov_b32 v163, v167
    s_mov_b32 exec_lo, 0x40004
    s_mov_b32 exec_hi, 0x40004
    v_mov_b32 v160, v168
    v_mov_b32 v161, v169
    v_mov_b32 v162, v170
    v_mov_b32 v163, v171
    s_mov_b32 exec_lo, 0x80008
    s_mov_b32 exec_hi, 0x80008
    v_mov_b32 v160, v172
    v_mov_b32 v161, v173
    v_mov_b32 v162, v174
    v_mov_b32 v163, v175
    s_mov_b32 exec_lo, 0x100010
    s_mov_b32 exec_hi, 0x100010
    v_mov_b32 v160, v176
    v_mov_b32 v161, v177
    v_mov_b32 v162, v178
    v_mov_b32 v163, v179
    s_mov_b32 exec_lo, 0x200020
    s_mov_b32 exec_hi, 0x200020
    v_mov_b32 v160, v180
    v_mov_b32 v161, v181
    v_mov_b32 v162, v182
    v_mov_b32 v163, v183
    s_mov_b32 exec_lo, 0x400040
    s_mov_b32 exec_hi, 0x400040
    v_mov_b32 v160, v184
    v_mov_b32 v161, v185
    v_mov_b32 v162, v186
    v_mov_b32 v163, v187
    s_mov_b32 exec_lo, 0x800080
    s_mov_b32 exec_hi, 0x800080
    v_mov_b32 v160, v188
    v_mov_b32 v161, v189
    v_mov_b32 v162, v190
    v_mov_b32 v163, v191
    s_mov_b64 exec, -1
    v_add_u32 v160, 0x200, v160
    v_add_u32 v161, 0x200, v161
    v_add_u32 v162, 0x200, v162
    v_add_u32 v163, 0x200, v163
    v_bfi_b32 v160, v157, s52, v160
    v_bfi_b32 v161, v157, s67, v161
    v_bfi_b32 v162, v157, s52, v162
    v_bfi_b32 v163, v157, s67, v163
L_hq:
    ds_read_b32 v20, v4 offset:8
    s_sub_u32 s53, s53, 1
    s_cbranch_scc1 L_end
    s_waitcnt lgkmcnt(0)
    v_readfirstlane_b32 s78, v20
    s_nop 0
    s_cmp_eq_u32 s78, 0
    s_cbranch_scc1 L_hq
    s_lshl_b32 s61, s51, 9
    s_add_u32 s61, s61, 0x20000
    v_lshlrev_b32 v144, 4, v2
    v_lshl_add_u32 v144, v3, 6, v144
    s_mov_b32 exec_lo, 0xff00ff
    s_mov_b32 exec_hi, 0xff00ff
    s_cmp_eq_u32 s78, 2
    s_cbranch_scc1 L_sl_77
    buffer_store_dwordx4 v[160:163], v144, s[28:31], s61 offen sc1
    s_branch L_sd_78
L_sl_77:
    buffer_store_dwordx4 v[160:163], v144, s[28:31], s61 offen
L_sd_78:
    s_mov_b64 exec, -1
    s_cmp_eq_u32 s50, 31
    s_cbranch_scc0 L_va_79e
    s_mov_b32 s61, 256
    s_cmp_eq_u32 s78, 2
    s_cbranch_scc0 L_va_79p
    s_lshl_b32 s61, s74, 7
    s_add_u32 s61, s61, 0x50000
    s_lshl_b32 s62, s52, 8
    v_lshlrev_b32 v125, 2, v0
    s_mov_b32 exec_hi, 0
L_va_79:
    buffer_load_dword v124, v125, s[28:31], s61 offen nt
    s_sub_u32 s53, s53, 1
    s_cbranch_scc1 L_end
    s_waitcnt vmcnt(0)
    v_xor_b32 v124, s62, v124
    v_cmp_lt_u32 vcc, 0xff, v124
    s_nop 0
    s_cbranch_vccnz L_va_79
    s_mov_b64 exec, -1
    v_and_b32 v124, 15, v124
    s_nop 1
    v_add_u32_dpp v124, v124, v124 row_ror:8 row_mask:0xf bank_mask:0xf
    s_nop 1
    v_add_u32_dpp v124, v124, v124 row_ror:4 row_mask:0xf bank_mask:0xf
    s_nop 1
    v_add_u32_dpp v124, v124, v124 row_ror:2 row_mask:0xf bank_mask:0xf
    s_nop 1
    v_add_u32_dpp v124, v124, v124 row_ror:1 row_mask:0xf bank_mask:0xf
    s_nop 0
    v_readlane_b32 s61, v124, 0
    v_readlane_b32 s62, v124, 16
    s_nop 0
    s_add_u32 s61, s61, s62
L_va_79p:
    s_getreg_b32 s62, hwreg(HW_REG_XCC_ID, 2, 1)
    s_lshl_b32 s62, s62, 13
    s_add_u32 s61, s61, s62
    v_mov_b32 v124, s52
    v_mov_b32 v125, s61
    s_lshl_b32 s61, s74, 7
    s_add_u32 s61, s61, 0x51000
    s_mov_b64 exec, 1
    buffer_store_dwordx2 v[124:125], off, s[28:31], s61 sc1
    s_mov_b64 exec, -1
L_va_79e:
    s_and_b32 s61, s51, 0xf8
    s_lshl_b32 s61, s61, 9
    s_and_b32 s62, s51, 7
    s_lshl_b32 s62, s62, 5
    s_add_u32 s61, s61, s62
    s_add_u32 s59, s61, 0x20000
    v_bfe_u32 v146, v0, 1, 4
    v_lshlrev_b32 v146, 8, v146
    v_and_b32 v147, 1, v0
    v_lshl_add_u32 v146, v147, 4, v146
    s_cmp_gt_i32 s54, 12
    s_cbranch_scc1 L_fok_80
L_fp_81:
    ds_read_b64 v[144:145], v4
    s_sub_u32 s53, s53, 1
    s_cbranch_scc1 L_end
    s_waitcnt lgkmcnt(0)
    v_readfirstlane_b32 s54, v144
    v_readfirstlane_b32 s68, v145
    s_cmp_gt_i32 s54, 12
    s_cbranch_scc0 L_fp_81
L_fok_80:
L_f1poll:
    buffer_load_dwordx4 v[60:63], v146, s[28:31], s59 offen sc1
    s_sub_u32 s53, s53, 1
    s_cbranch_scc1 L_end
    s_waitcnt vmcnt(0)
    v_xor_b32 v60, s75, v60
    v_xor_b32 v61, s67, v61
    v_xor_b32 v62, s75, v62
    v_xor_b32 v63, s67, v63
    v_or3_b32 v144, v60, v61, v62
    v_bitop3_b32 v144, v144, v63, v157 bitop3:0xa8
    v_cmp_ne_u32 vcc, 0, v144
    s_nop 0
    s_cbranch_vccnz L_f1poll
    v_add_f32_dpp v60, v60, v60 row_ror:4 row_mask:0xf bank_mask:0xf
    v_add_f32_dpp v61, v61, v61 row_ror:4 row_mask:0xf bank_mask:0xf
    v_add_f32_dpp v62, v62, v62 row_ror:4 row_mask:0xf bank_mask:0xf
    v_add_f32_dpp v63, v63, v63 row_ror:4 row_mask:0xf bank_mask:0xf
    v_add_f32_dpp v60, v60, v60 row_ror:8 row_mask:0xf bank_mask:0xf
    v_add_f32_dpp v61, v61, v61 row_ror:8 row_mask:0xf bank_mask:0xf
    v_add_f32_dpp v62, v62, v62 row_ror:8 row_mask:0xf bank_mask:0xf
    v_add_f32_dpp v63, v63, v63 row_ror:8 row_mask:0xf bank_mask:0xf
    v_mov_b32 v132, v60
    v_mov_b32 v133, v61
    v_mov_b32 v134, v62
    v_mov_b32 v135, v63
    v_permlane16_swap_b32 v60, v132
    v_permlane16_swap_b32 v61, v133
    v_permlane16_swap_b32 v62, v134
    v_permlane16_swap_b32 v63, v135
    v_add_f32 v60, v60, v132
    v_add_f32 v61, v61, v133
    v_add_f32 v62, v62, v134
    v_add_f32 v63, v63, v135
    v_cvt_pk_bf16_f32 v60, v60, v60
    v_and_b32 v60, 0xffff0000, v60
    v_cvt_pk_bf16_f32 v61, v61, v61
    v_and_b32 v61, 0xffff0000, v61
    v_cvt_pk_bf16_f32 v62, v62, v62
    v_and_b32 v62, 0xffff0000, v62
    v_cvt_pk_bf16_f32 v63, v63, v63
    v_and_b32 v63, 0xffff0000, v63
    v_mov_b32_dpp v68, v60 quad_perm:[2,3,2,3] row_mask:0xf bank_mask:0xf
    v_mov_b32_dpp v69, v61 quad_perm:[2,3,2,3] row_mask:0xf bank_mask:0xf
    v_mov_b32_dpp v70, v62 quad_perm:[2,3,2,3] row_mask:0xf bank_mask:0xf
    v_mov_b32_dpp v71, v63 quad_perm:[2,3,2,3] row_mask:0xf bank_mask:0xf
    v_mul_f32 v64, v60, v60
    v_mul_f32 v65, v61, v61
    v_mul_f32 v66, v62, v62
    v_mul_f32 v67, v63, v63
    v_mul_f32 v64, 0x3d372713, v64
    v_mul_f32 v65, 0x3d372713, v65
    v_mul_f32 v66, 0x3d372713, v66
    v_mul_f32 v67, 0x3d372713, v67
    v_fma_f32 v64, v64, v60, v60
    v_fma_f32 v65, v65, v61, v61
    v_fma_f32 v66, v66, v62, v62
    v_fma_f32 v67, v67, v63, v63
    v_mul_f32 v64, 0xc0135761, v64
    v_mul_f32 v65, 0xc0135761, v65
    v_mul_f32 v66, 0xc0135761, v66
    v_mul_f32 v67, 0xc0135761, v67
    v_exp_f32 v64, v64
    v_exp_f32 v65, v65
    v_exp_f32 v66, v66
    v_exp_f32 v67, v67
    v_add_f32 v64, 1.0, v64
    v_add_f32 v65, 1.0, v65
    v_add_f32 v66, 1.0, v66
    v_add_f32 v67, 1.0, v67
    v_rcp_f32 v64, v64
    v_rcp_f32 v65, v65
    v_rcp_f32 v66, v66
    v_rcp_f32 v67, v67
    v_mul_f32 v64, v60, v64
    v_mul_f32 v65, v61, v65
    v_mul_f32 v66, v62, v66
    v_mul_f32 v67, v63, v67
    v_cvt_pk_bf16_f32 v64, v64, v64
    v_and_b32 v64, 0xffff0000, v64
    v_cvt_pk_bf16_f32 v65, v65, v65
    v_and_b32 v65, 0xffff0000, v65
    v_cvt_pk_bf16_f32 v66, v66, v66
    v_and_b32 v66, 0xffff0000, v66
    v_cvt_pk_bf16_f32 v67, v67, v67
    v_and_b32 v67, 0xffff0000, v67
    v_mul_f32 v64, v64, v68
    v_mul_f32 v65, v65, v69
    v_mul_f32 v66, v66, v70
    v_mul_f32 v67, v67, v71
    v_cvt_pk_bf16_f32 v64, v64, v64
    v_and_b32 v64, 0xffff0000, v64
    v_cvt_pk_bf16_f32 v65, v65, v65
    v_and_b32 v65, 0xffff0000, v65
    v_cvt_pk_bf16_f32 v66, v66, v66
    v_and_b32 v66, 0xffff0000, v66
    v_cvt_pk_bf16_f32 v67, v67, v67
    v_and_b32 v67, 0xffff0000, v67
    v_mov_b32 v92, 0
    v_mov_b32 v93, 0
    v_mov_b32 v94, 0
    v_mov_b32 v95, 0
    v_mov_b32 v96, 0
    v_mov_b32 v97, 0
    v_mov_b32 v98, 0
    v_mov_b32 v99, 0
    v_lshlrev_b32 v100, 16, v28
    v_and_b32 v101, 0xffff0000, v28
    v_lshlrev_b32 v102, 16, v29
    v_and_b32 v103, 0xffff0000, v29
    v_lshlrev_b32 v104, 16, v30
    v_and_b32 v105, 0xffff0000, v30
    v_lshlrev_b32 v106, 16, v31
    v_and_b32 v107, 0xffff0000, v31
    v_fmac_f32_dpp v92, v64, v100 quad_perm:[0,0,0,0] row_mask:0xf bank_mask:0xf
    v_fmac_f32_dpp v93, v64, v101 quad_perm:[0,0,0,0] row_mask:0xf bank_mask:0xf
    v_fmac_f32_dpp v94, v64, v102 quad_perm:[0,0,0,0] row_mask:0xf bank_mask:0xf
    v_fmac_f32_dpp v95, v64, v103 quad_perm:[0,0,0,0] row_mask:0xf bank_mask:0xf
    v_fmac_f32_dpp v96, v64, v104 quad_perm:[0,0,0,0] row_mask:0xf bank_mask:0xf
    v_fmac_f32_dpp v97, v64, v105 quad_perm:[0,0,0,0] row_mask:0xf bank_mask:0xf
    v_fmac_f32_dpp v98, v64, v106 quad_perm:[0,0,0,0] row_mask:0xf bank_mask:0xf
    v_fmac_f32_dpp v99, v64, v107 quad_perm:[0,0,0,0] row_mask:0xf bank_mask:0xf
    v_lshlrev_b32 v100, 16, v32
    v_and_b32 v101, 0xffff0000, v32
    v_lshlrev_b32 v102, 16, v33
    v_and_b32 v103, 0xffff0000, v33
    v_lshlrev_b32 v104, 16, v34
    v_and_b32 v105, 0xffff0000, v34
    v_lshlrev_b32 v106, 16, v35
    v_and_b32 v107, 0xffff0000, v35
    v_fmac_f32_dpp v92, v65, v100 quad_perm:[0,0,0,0] row_mask:0xf bank_mask:0xf
    v_fmac_f32_dpp v93, v65, v101 quad_perm:[0,0,0,0] row_mask:0xf bank_mask:0xf
    v_fmac_f32_dpp v94, v65, v102 quad_perm:[0,0,0,0] row_mask:0xf bank_mask:0xf
    v_fmac_f32_dpp v95, v65, v103 quad_perm:[0,0,0,0] row_mask:0xf bank_mask:0xf
    v_fmac_f32_dpp v96, v65, v104 quad_perm:[0,0,0,0] row_mask:0xf bank_mask:0xf
    v_fmac_f32_dpp v97, v65, v105 quad_perm:[0,0,0,0] row_mask:0xf bank_mask:0xf
    v_fmac_f32_dpp v98, v65, v106 quad_perm:[0,0,0,0] row_mask:0xf bank_mask:0xf
    v_fmac_f32_dpp v99, v65, v107 quad_perm:[0,0,0,0] row_mask:0xf bank_mask:0xf
    v_lshlrev_b32 v100, 16, v36
    v_and_b32 v101, 0xffff0000, v36
    v_lshlrev_b32 v102, 16, v37
    v_and_b32 v103, 0xffff0000, v37
    v_lshlrev_b32 v104, 16, v38
    v_and_b32 v105, 0xffff0000, v38
    v_lshlrev_b32 v106, 16, v39
    v_and_b32 v107, 0xffff0000, v39
    v_fmac_f32_dpp v92, v66, v100 quad_perm:[0,0,0,0] row_mask:0xf bank_mask:0xf
    v_fmac_f32_dpp v93, v66, v101 quad_perm:[0,0,0,0] row_mask:0xf bank_mask:0xf
    v_fmac_f32_dpp v94, v66, v102 quad_perm:[0,0,0,0] row_mask:0xf bank_mask:0xf
    v_fmac_f32_dpp v95, v66, v103 quad_perm:[0,0,0,0] row_mask:0xf bank_mask:0xf
    v_fmac_f32_dpp v96, v66, v104 quad_perm:[0,0,0,0] row_mask:0xf bank_mask:0xf
    v_fmac_f32_dpp v97, v66, v105 quad_perm:[0,0,0,0] row_mask:0xf bank_mask:0xf
    v_fmac_f32_dpp v98, v66, v106 quad_perm:[0,0,0,0] row_mask:0xf bank_mask:0xf
    v_fmac_f32_dpp v99, v66, v107 quad_perm:[0,0,0,0] row_mask:0xf bank_mask:0xf
    v_lshlrev_b32 v100, 16, v40
    v_and_b32 v101, 0xffff0000, v40
    v_lshlrev_b32 v102, 16, v41
    v_and_b32 v103, 0xffff0000, v41
    v_lshlrev_b32 v104, 16, v42
    v_and_b32 v105, 0xffff0000, v42
    v_lshlrev_b32 v106, 16, v43
    v_and_b32 v107, 0xffff0000, v43
    v_fmac_f32_dpp v92, v67, v100 quad_perm:[0,0,0,0] row_mask:0xf bank_mask:0xf
    v_fmac_f32_dpp v93, v67, v101 quad_perm:[0,0,0,0] row_mask:0xf bank_mask:0xf
    v_fmac_f32_dpp v94, v67, v102 quad_perm:[0,0,0,0] row_mask:0xf bank_mask:0xf
    v_fmac_f32_dpp v95, v67, v103 quad_perm:[0,0,0,0] row_mask:0xf bank_mask:0xf
    v_fmac_f32_dpp v96, v67, v104 quad_perm:[0,0,0,0] row_mask:0xf bank_mask:0xf
    v_fmac_f32_dpp v97, v67, v105 quad_perm:[0,0,0,0] row_mask:0xf bank_mask:0xf
    v_fmac_f32_dpp v98, v67, v106 quad_perm:[0,0,0,0] row_mask:0xf bank_mask:0xf
    v_fmac_f32_dpp v99, v67, v107 quad_perm:[0,0,0,0] row_mask:0xf bank_mask:0xf
    v_lshlrev_b32 v100, 16, v44
    v_and_b32 v101, 0xffff0000, v44
    v_lshlrev_b32 v102, 16, v45
    v_and_b32 v103, 0xffff0000, v45
    v_lshlrev_b32 v104, 16, v46
    v_and_b32 v105, 0xffff0000, v46
    v_lshlrev_b32 v106, 16, v47
    v_and_b32 v107, 0xffff0000, v47
    v_fmac_f32_dpp v92, v64, v100 quad_perm:[1,1,1,1] row_mask:0xf bank_mask:0xf
    v_fmac_f32_dpp v93, v64, v101 quad_perm:[1,1,1,1] row_mask:0xf bank_mask:0xf
    v_fmac_f32_dpp v94, v64, v102 quad_perm:[1,1,1,1] row_mask:0xf bank_mask:0xf
    v_fmac_f32_dpp v95, v64, v103 quad_perm:[1,1,1,1] row_mask:0xf bank_mask:0xf
    v_fmac_f32_dpp v96, v64, v104 quad_perm:[1,1,1,1] row_mask:0xf bank_mask:0xf
    v_fmac_f32_dpp v97, v64, v105 quad_perm:[1,1,1,1] row_mask:0xf bank_mask:0xf
    v_fmac_f32_dpp v98, v64, v106 quad_perm:[1,1,1,1] row_mask:0xf bank_mask:0xf
    v_fmac_f32_dpp v99, v64, v107 quad_perm:[1,1,1,1] row_mask:0xf bank_mask:0xf
    v_lshlrev_b32 v100, 16, v48
    v_and_b32 v101, 0xffff0000, v48
    v_lshlrev_b32 v102, 16, v49
    v_and_b32 v103, 0xffff0000, v49
    v_lshlrev_b32 v104, 16, v50
    v_and_b32 v105, 0xffff0000, v50
    v_lshlrev_b32 v106, 16, v51
    v_and_b32 v107, 0xffff0000, v51
    v_fmac_f32_dpp v92, v65, v100 quad_perm:[1,1,1,1] row_mask:0xf bank_mask:0xf
    v_fmac_f32_dpp v93, v65, v101 quad_perm:[1,1,1,1] row_mask:0xf bank_mask:0xf
    v_fmac_f32_dpp v94, v65, v102 quad_perm:[1,1,1,1] row_mask:0xf bank_mask:0xf
    v_fmac_f32_dpp v95, v65, v103 quad_perm:[1,1,1,1] row_mask:0xf bank_mask:0xf
    v_fmac_f32_dpp v96, v65, v104 quad_perm:[1,1,1,1] row_mask:0xf bank_mask:0xf
    v_fmac_f32_dpp v97, v65, v105 quad_perm:[1,1,1,1] row_mask:0xf bank_mask:0xf
    v_fmac_f32_dpp v98, v65, v106 quad_perm:[1,1,1,1] row_mask:0xf bank_mask:0xf
    v_fmac_f32_dpp v99, v65, v107 quad_perm:[1,1,1,1] row_mask:0xf bank_mask:0xf
    v_lshlrev_b32 v100, 16, v52
    v_and_b32 v101, 0xffff0000, v52
    v_lshlrev_b32 v102, 16, v53
    v_and_b32 v103, 0xffff0000, v53
    v_lshlrev_b32 v104, 16, v54
    v_and_b32 v105, 0xffff0000, v54
    v_lshlrev_b32 v106, 16, v55
    v_and_b32 v107, 0xffff0000, v55
    v_fmac_f32_dpp v92, v66, v100 quad_perm:[1,1,1,1] row_mask:0xf bank_mask:0xf
    v_fmac_f32_dpp v93, v66, v101 quad_perm:[1,1,1,1] row_mask:0xf bank_mask:0xf
    v_fmac_f32_dpp v94, v66, v102 quad_perm:[1,1,1,1] row_mask:0xf bank_mask:0xf
    v_fmac_f32_dpp v95, v66, v103 quad_perm:[1,1,1,1] row_mask:0xf bank_mask:0xf
    v_fmac_f32_dpp v96, v66, v104 quad_perm:[1,1,1,1] row_mask:0xf bank_mask:0xf
    v_fmac_f32_dpp v97, v66, v105 quad_perm:[1,1,1,1] row_mask:0xf bank_mask:0xf
    v_fmac_f32_dpp v98, v66, v106 quad_perm:[1,1,1,1] row_mask:0xf bank_mask:0xf
    v_fmac_f32_dpp v99, v66, v107 quad_perm:[1,1,1,1] row_mask:0xf bank_mask:0xf
    v_lshlrev_b32 v100, 16, v56
    v_and_b32 v101, 0xffff0000, v56
    v_lshlrev_b32 v102, 16, v57
    v_and_b32 v103, 0xffff0000, v57
    v_lshlrev_b32 v104, 16, v58
    v_and_b32 v105, 0xffff0000, v58
    v_lshlrev_b32 v106, 16, v59
    v_and_b32 v107, 0xffff0000, v59
    v_fmac_f32_dpp v92, v67, v100 quad_perm:[1,1,1,1] row_mask:0xf bank_mask:0xf
    v_fmac_f32_dpp v93, v67, v101 quad_perm:[1,1,1,1] row_mask:0xf bank_mask:0xf
    v_fmac_f32_dpp v94, v67, v102 quad_perm:[1,1,1,1] row_mask:0xf bank_mask:0xf
    v_fmac_f32_dpp v95, v67, v103 quad_perm:[1,1,1,1] row_mask:0xf bank_mask:0xf
    v_fmac_f32_dpp v96, v67, v104 quad_perm:[1,1,1,1] row_mask:0xf bank_mask:0xf
    v_fmac_f32_dpp v97, v67, v105 quad_perm:[1,1,1,1] row_mask:0xf bank_mask:0xf
    v_fmac_f32_dpp v98, v67, v106 quad_perm:[1,1,1,1] row_mask:0xf bank_mask:0xf
    v_fmac_f32_dpp v99, v67, v107 quad_perm:[1,1,1,1] row_mask:0xf bank_mask:0xf
    v_add_u32 v92, 0x200, v92
    v_add_u32 v93, 0x200, v93
    v_add_u32 v94, 0x200, v94
    v_add_u32 v95, 0x200, v95
    v_bfi_b32 v92, v157, s52, v92
    v_bfi_b32 v93, v157, s67, v93
    v_bfi_b32 v94, v157, s52, v94
    v_bfi_b32 v95, v157, s67, v95
    v_add_u32 v96, 0x200, v96
    v_add_u32 v97, 0x200, v97
    v_add_u32 v98, 0x200, v98
    v_add_u32 v99, 0x200, v99
    v_bfi_b32 v96, v157, s52, v96
    v_bfi_b32 v97, v157, s67, v97
    v_bfi_b32 v98, v157, s52, v98
    v_bfi_b32 v99, v157, s67, v99
    s_lshl_b32 s61, s51, 7
    s_add_u32 s61, s61, 0x180000
    s_add_u32 s62, s61, 229376
    v_lshrrev_b32 v144, 3, v0
    v_mul_u32_u24 v144, 28672, v144
    v_and_b32 v145, 7, v0
    v_lshl_add_u32 v144, v145, 4, v144
    s_cmp_eq_u32 s78, 2
    s_cbranch_scc1 L_sl_82
    buffer_store_dwordx4 v[92:95], v144, s[28:31], s61 offen sc1
    buffer_store_dwordx4 v[96:99], v144, s[28:31], s62 offen sc1
    s_branch L_sd_83
L_sl_82:
    buffer_store_dwordx4 v[92:95], v144, s[28:31], s61 offen
    buffer_store_dwordx4 v[96:99], v144, s[28:31], s62 offen
L_sd_83:
    s_branch L_ffndone
L_noffn:
    v_mov_b32 v20, 0x7fffffff
    ds_write_b32 v5, v20
L_hq2:
    ds_read_b32 v20, v4 offset:8
    s_sub_u32 s53, s53, 1
    s_cbranch_scc1 L_end
    s_waitcnt lgkmcnt(0)
    v_readfirstlane_b32 s78, v20
    s_nop 0
    s_cmp_eq_u32 s78, 0
    s_cbranch_scc1 L_hq2
    s_cmp_eq_u32 s50, 31
    s_cbranch_scc0 L_va_84e
    s_mov_b32 s61, 256
    s_cmp_eq_u32 s78, 2
    s_cbranch_scc0 L_va_84p
    s_lshl_b32 s61, s74, 7
    s_add_u32 s61, s61, 0x50000
    s_lshl_b32 s62, s52, 8
    v_lshlrev_b32 v125, 2, v0
    s_mov_b32 exec_hi, 0
L_va_84:
    buffer_load_dword v124, v125, s[28:31], s61 offen nt
    s_sub_u32 s53, s53, 1
    s_cbranch_scc1 L_end
    s_waitcnt vmcnt(0)
    v_xor_b32 v124, s62, v124
    v_cmp_lt_u32 vcc, 0xff, v124
    s_nop 0
    s_cbranch_vccnz L_va_84
    s_mov_b64 exec, -1
    v_and_b32 v124, 15, v124
    s_nop 1
    v_add_u32_dpp v124, v124, v124 row_ror:8 row_mask:0xf bank_mask:0xf
    s_nop 1
    v_add_u32_dpp v124, v124, v124 row_ror:4 row_mask:0xf bank_mask:0xf
    s_nop 1
    v_add_u32_dpp v124, v124, v124 row_ror:2 row_mask:0xf bank_mask:0xf
    s_nop 1
    v_add_u32_dpp v124, v124, v124 row_ror:1 row_mask:0xf bank_mask:0xf
    s_nop 0
    v_readlane_b32 s61, v124, 0
    v_readlane_b32 s62, v124, 16
    s_nop 0
    s_add_u32 s61, s61, s62
L_va_84p:
    s_getreg_b32 s62, hwreg(HW_REG_XCC_ID, 2, 1)
    s_lshl_b32 s62, s62, 13
    s_add_u32 s61, s61, s62
    v_mov_b32 v124, s52
    v_mov_b32 v125, s61
    s_lshl_b32 s61, s74, 7
    s_add_u32 s61, s61, 0x51000
    s_mov_b64 exec, 1
    buffer_store_dwordx2 v[124:125], off, s[28:31], s61 sc1
    s_mov_b64 exec, -1
L_va_84e:
    s_waitcnt vmcnt(0)
L_ffndone:
    v_lshlrev_b32 v17, 1, v2
    v_lshlrev_b32 v148, 7, v0
    v_lshrrev_b32 v150, 2, v0
    v_lshlrev_b32 v150, 4, v150
    s_lshl_b32 s61, s48, 16
    s_lshl_b32 s62, s49, 11
    s_add_u32 s61, s61, s62
    s_add_u32 s55, s61, 0x280000
    v_bfe_u32 v151, v0, 4, 1
    v_lshlrev_b32 v151, 17, v151
    v_bfe_u32 v144, v0, 3, 1
    v_lshl_add_u32 v151, v144, 11, v151
    v_and_b32 v145, 0x70, v156
    v_add_u32 v151, v151, v145
    v_lshlrev_b32 v187, 1, v145
    v_lshl_add_u32 v187, v144, 4, v187
    v_and_b32 v144, 0x100, v156
    v_add_u32 v187, v187, v144
    v_add_u32 v187, 141312, v187
    v_lshlrev_b32 v186, 3, v0
    v_add_u32 v186, 140288, v186
    s_and_b32 s56, s50, 3
    s_lshl_b32 s56, s56, 18
    s_add_u32 s56, s56, 0x400000
    s_bfe_u32 s62, s50, 0x10002
    s_lshl_b32 s62, s62, 12
    s_add_u32 s56, s56, s62
    s_bfe_u32 s62, s50, 0x10003
    s_lshl_b32 s62, s62, 14
    s_add_u32 s56, s56, s62
    s_bfe_u32 s62, s50, 0x10004
    s_lshl_b32 s62, s62, 7
    s_add_u32 s56, s56, s62
    s_bfe_u32 s62, s74, 0x10000
    s_lshl_b32 s62, s62, 8
    s_add_u32 s56, s56, s62
    s_bfe_u32 s62, s74, 0x10001
    s_lshl_b32 s62, s62, 9
    s_add_u32 s56, s56, s62
    s_bfe_u32 s62, s74, 0x10002
    s_lshl_b32 s62, s62, 10
    s_add_u32 s56, s56, s62
    v_bfe_u32 v144, v0, 0, 1
    v_lshlrev_b32 v152, 12, v144
    v_bfe_u32 v144, v0, 1, 1
    v_lshl_add_u32 v152, v144, 14, v152
    v_bfe_u32 v144, v0, 2, 1
    v_lshl_add_u32 v152, v144, 7, v152
    v_bfe_u32 v144, v0, 3, 1
    v_lshl_add_u32 v152, v144, 8, v152
    v_bfe_u32 v144, v0, 4, 1
    v_lshl_add_u32 v152, v144, 9, v152
    v_bfe_u32 v144, v0, 5, 1
    v_lshl_add_u32 v152, v144, 10, v152
    v_bfe_u32 v144, v0, 1, 1
    v_lshlrev_b32 v153, 12, v144
    v_bfe_u32 v144, v0, 2, 1
    v_lshl_add_u32 v153, v144, 14, v153
    v_and_b32 v144, 1, v0
    v_lshl_add_u32 v153, v144, 6, v153
    s_lshl_b32 s57, s74, 17
    s_add_u32 s57, s57, 0x400000
    s_mov_b32 s14, s57
    s_bfe_u32 s62, s50, 0x10000
    s_lshl_b32 s62, s62, 7
    s_add_u32 s14, s14, s62
    s_bfe_u32 s62, s50, 0x10001
    s_lshl_b32 s62, s62, 8
    s_add_u32 s14, s14, s62
    s_bfe_u32 s62, s50, 0x10002
    s_lshl_b32 s62, s62, 9
    s_add_u32 s14, s14, s62
    s_bfe_u32 s62, s50, 0x10003
    s_lshl_b32 s62, s62, 10
    s_add_u32 s14, s14, s62
    s_bfe_u32 s62, s50, 0x10004
    s_lshl_b32 s62, s62, 11
    s_add_u32 s14, s14, s62
    s_bfe_u32 s62, s50, 0x10000
    s_lshl_b32 s62, s62, 11
    s_add_u32 s57, s57, s62
    s_and_b32 s61, s81, 1
    s_lshl_b32 s61, s61, 3
    s_lshr_b32 s62, s81, 4
    s_add_u32 s61, s61, s62
    s_bfe_u32 s62, s81, 0x30001
    s_lshl_b32 s62, s62, 4
    s_add_u32 s57, s57, s62
    s_lshl_b32 s59, s61, 10
    s_add_u32 s59, s59, s62
    s_add_u32 s59, s59, 0x40000
    s_and_b32 s80, s50, 3
    s_add_u32 s80, s80, 20
    s_getreg_b32 s82, hwreg(HW_REG_XCC_ID, 0, 1)
    s_mul_i32 s82, s82, -92
    s_add_i32 s82, s82, 30
    s_add_i32 s82, s82, s50
    s_lshl_b32 s58, s52, 8
    v_mov_b32 v30, 16
    v_mov_b32 v31, s58
    v_mov_b32 v34, 0x100
    v_mov_b32 v32, 0
    s_mul_i32 s60, s74, 4352
    s_add_u32 s60, s60, 0x1000
    v_lshl_add_u32 v29, v0, 2, s60
    s_lshl_b32 s79, s50, 2
    s_add_u32 s79, s79, s60
    v_and_b32 v30, 3, v0
    v_add_u32 v30, 16, v30
L_ctl_85:
    s_cmp_gt_i32 s54, s80
    s_cbranch_scc1 L_fok_87
L_fp_88:
    ds_read_b64 v[144:145], v4
    s_sub_u32 s53, s53, 1
    s_cbranch_scc1 L_end
    s_waitcnt lgkmcnt(0)
    v_readfirstlane_b32 s54, v144
    v_readfirstlane_b32 s68, v145
    s_cmp_gt_i32 s54, s80
    s_cbranch_scc0 L_fp_88
L_fok_87:
    s_cmp_eq_u32 s78, 2
    s_cbranch_scc0 L_cs_86
    s_add_u32 s61, s58, s80
    v_mov_b32 v28, s61
    s_mov_b64 exec, 1
    buffer_store_dword v28, off, s[28:31], s79
    s_mov_b32 exec_lo, 0xffffffff
    s_mov_b32 exec_hi, 0x0
    buffer_load_dword v32, v29, s[28:31], 0 offen sc1
    s_waitcnt vmcnt(0)
    v_sub_u32 v32, v32, v31
    v_cmp_lt_u32 vcc, v32, v34
    s_nop 1
    v_cndmask_b32 v32, v30, v32, vcc
    s_mov_b64 exec, -1
    s_nop 0
    v_add_u32_dpp v32, v32, v32 row_ror:8 row_mask:0xf bank_mask:0xf
    s_nop 1
    v_add_u32_dpp v32, v32, v32 row_ror:4 row_mask:0xf bank_mask:0xf
    s_nop 1
    v_add_u32_dpp v32, v32, v32 row_ror:2 row_mask:0xf bank_mask:0xf
    s_nop 1
    v_add_u32_dpp v32, v32, v32 row_ror:1 row_mask:0xf bank_mask:0xf
    s_nop 0
    v_readlane_b32 s61, v32, 0
    v_readlane_b32 s62, v32, 16
    v_readlane_b32 s83, v32, 32
    s_add_u32 s61, s61, s62
    v_mov_b32 v32, 0
    s_lshl_b32 s61, s61, 3
    s_lshl_b32 s62, s80, 8
    s_sub_i32 s61, s61, s62
    s_add_i32 s61, s61, s82
    s_cmp_lt_i32 s61, -870
    s_cselect_b32 s62, 1, 0
    s_cmp_gt_i32 s61, -230
    s_cselect_b32 s62, 2, s62
    v_mov_b32 v144, s62
    ds_write_b32 v4, v144 offset:12
L_cs_86:
    s_add_u32 s80, s80, 4
    s_cmp_le_u32 s80, 24
    s_cbranch_scc1 L_ctl_85
L_ctl_85x:
    v_and_b32 v146, 0x380, v156
    s_mov_b32 s83, 0x51000
L_vtpoll:
    buffer_load_dwordx2 v[60:61], v146, s[28:31], s83 offen sc1
    s_sub_u32 s53, s53, 1
    s_cbranch_scc1 L_end
    s_waitcnt vmcnt(0)
    v_cmp_ne_u32 vcc, s52, v60
    s_nop 0
    s_cbranch_vccnz L_vtpoll
    v_and_b32 v144, 0x3ff, v61
    s_nop 1
    v_add_u32_dpp v144, v144, v144 row_ror:8 row_mask:0xf bank_mask:0xf
    v_mov_b32 v145, v144
    s_nop 1
    v_permlane16_swap_b32 v144, v145
    v_add_u32 v144, v144, v145
    v_mov_b32 v145, v144
    s_nop 1
    v_permlane32_swap_b32 v144, v145
    v_add_u32 v144, v144, v145
    v_cmp_gt_u32 vcc, 2048, v144
    s_nop 1
    v_cndmask_b32 v144, 0, 1, vcc
    v_lshlrev_b32 v144, 13, v144
    v_xor_b32 v144, v144, v61
    v_and_b32 v144, 0x2000, v144
    s_and_b32 s61, s50, 3
    s_lshl_b32 s61, s61, 4
    v_readlane_b32 s62, v144, s61
    s_add_u32 s61, s61, 8
    v_readlane_b32 s61, v144, s61
    s_mov_b64 exec, 0xffff
    v_add_u32 v151, s62, v151
    s_mov_b32 exec_lo, 0xffff0000
    v_add_u32 v151, s61, v151
    s_mov_b64 exec, -1
    s_lshl_b32 s61, s74, 3
    v_readlane_b32 s61, v144, s61
    s_nop 0
    s_add_u32 s57, s57, s61
    s_add_u32 s14, s14, s61
    s_mov_b64 exec, 255
    buffer_load_dword v60, v153, s[28:31], s14 offen sc1
    s_mov_b64 exec, -1
L_ctl_89:
    s_cmp_gt_i32 s54, s80
    s_cbranch_scc1 L_fok_91
L_fp_92:
    ds_read_b64 v[144:145], v4
    s_sub_u32 s53, s53, 1
    s_cbranch_scc1 L_end
    s_waitcnt lgkmcnt(0)
    v_readfirstlane_b32 s54, v144
    v_readfirstlane_b32 s68, v145
    s_cmp_gt_i32 s54, s80
    s_cbranch_scc0 L_fp_92
L_fok_91:
    s_cmp_eq_u32 s78, 2
    s_cbranch_scc0 L_cs_90
    s_add_u32 s61, s58, s80
    v_mov_b32 v28, s61
    s_mov_b64 exec, 1
    buffer_store_dword v28, off, s[28:31], s79
    s_mov_b32 exec_lo, 0xffffffff
    s_mov_b32 exec_hi, 0x0
    buffer_load_dword v32, v29, s[28:31], 0 offen sc1
    s_waitcnt vmcnt(0)
    v_sub_u32 v32, v32, v31
    v_cmp_lt_u32 vcc, v32, v34
    s_nop 1
    v_cndmask_b32 v32, v30, v32, vcc
    s_mov_b64 exec, -1
    s_nop 0
    v_add_u32_dpp v32, v32, v32 row_ror:8 row_mask:0xf bank_mask:0xf
    s_nop 1
    v_add_u32_dpp v32, v32, v32 row_ror:4 row_mask:0xf bank_mask:0xf
    s_nop 1
    v_add_u32_dpp v32, v32, v32 row_ror:2 row_mask:0xf bank_mask:0xf
    s_nop 1
    v_add_u32_dpp v32, v32, v32 row_ror:1 row_mask:0xf bank_mask:0xf
    s_nop 0
    v_readlane_b32 s61, v32, 0
    v_readlane_b32 s62, v32, 16
    v_readlane_b32 s83, v32, 32
    s_add_u32 s61, s61, s62
    v_mov_b32 v32, 0
    s_lshl_b32 s61, s61, 3
    s_lshl_b32 s62, s80, 8
    s_sub_i32 s61, s61, s62
    s_add_i32 s61, s61, s82
    s_cmp_lt_i32 s61, -870
    s_cselect_b32 s62, 1, 0
    s_cmp_gt_i32 s61, -230
    s_cselect_b32 s62, 2, s62
    v_mov_b32 v144, s62
    ds_write_b32 v4, v144 offset:12
L_cs_90:
    s_add_u32 s80, s80, 4
    s_cmp_le_u32 s80, 28
    s_cbranch_scc1 L_ctl_89
L_ctl_89x:
    s_cmp_lt_u32 s50, 16
    s_cbranch_scc0 L_nob3
    s_mul_i32 s62, s50, 28672
    s_lshl_b32 s61, s94, 7
    s_add_u32 s62, s62, s61
    s_add_u32 s62, s62, 0x180000
    v_mov_b32 v72, 0
    v_mov_b32 v73, 0
    v_mov_b32 v74, 0
    v_mov_b32 v75, 0
    v_add_u32 v72, 0x200, v72
    v_add_u32 v73, 0x200, v73
    v_add_u32 v74, 0x200, v74
    v_add_u32 v75, 0x200, v75
    v_bfi_b32 v72, v157, s52, v72
    v_bfi_b32 v73, v157, s67, v73
    v_bfi_b32 v74, v157, s52, v74
    v_bfi_b32 v75, v157, s67, v75
L_b3poll:
    buffer_load_dwordx4 v[60:63], v156, s[28:31], s62 offen offset:0 sc1
    buffer_load_dwordx4 v[64:67], v156, s[28:31], s62 offen offset:1024 sc1
    buffer_load_dwordx4 v[68:71], v156, s[28:31], s62 offen offset:2048 sc1
    s_bitcmp1_b32 s74, 0
    s_cbranch_scc0 L_b3three
    buffer_load_dwordx4 v[72:75], v156, s[28:31], s62 offen offset:3072 sc1
L_b3three:
    s_sub_u32 s53, s53, 1
    s_cbranch_scc1 L_end
    s_waitcnt vmcnt(0)
    v_xor_b32 v76, s75, v60
    v_xor_b32 v77, s67, v61
    v_xor_b32 v78, s75, v62
    v_xor_b32 v79, s67, v63
    v_xor_b32 v80, s75, v64
    v_xor_b32 v81, s67, v65
    v_xor_b32 v82, s75, v66
    v_xor_b32 v83, s67, v67
    v_xor_b32 v84, s75, v68
    v_xor_b32 v85, s67, v69
    v_xor_b32 v86, s75, v70
    v_xor_b32 v87, s67, v71
    v_xor_b32 v88, s75, v72
    v_xor_b32 v89, s67, v73
    v_xor_b32 v90, s75, v74
    v_xor_b32 v91, s67, v75
    v_or3_b32 v144, v76, v77, v78
    v_or3_b32 v144, v144, v79, v80
    v_or3_b32 v144, v144, v81, v82
    v_or3_b32 v144, v144, v83, v84
    v_or3_b32 v144, v144, v85, v86
    v_or3_b32 v144, v144, v87, v88
    v_or3_b32 v144, v144, v89, v90
    v_bitop3_b32 v144, v144, v91, v157 bitop3:0xa8
    v_cmp_ne_u32 vcc, 0, v144
    s_nop 0
    s_cbranch_vccnz L_b3poll
    v_add_f32 v12, v76, v80
    v_add_f32 v136, v84, v88
    v_add_f32 v13, v77, v81
    v_add_f32 v137, v85, v89
    v_add_f32 v14, v78, v82
    v_add_f32 v138, v86, v90
    v_add_f32 v15, v79, v83
    v_add_f32 v139, v87, v91
    v_add_f32 v12, v12, v136
    v_add_f32 v13, v13, v137
    v_add_f32 v14, v14, v138
    v_add_f32 v15, v15, v139
    v_add_f32_dpp v12, v12, v12 row_ror:8 row_mask:0xf bank_mask:0xf
    v_add_f32_dpp v13, v13, v13 row_ror:8 row_mask:0xf bank_mask:0xf
    v_add_f32_dpp v14, v14, v14 row_ror:8 row_mask:0xf bank_mask:0xf
    v_add_f32_dpp v15, v15, v15 row_ror:8 row_mask:0xf bank_mask:0xf
    v_mov_b32 v132, v12
    v_mov_b32 v133, v13
    v_mov_b32 v134, v14
    v_mov_b32 v135, v15
    v_permlane16_swap_b32 v12, v132
    v_permlane16_swap_b32 v13, v133
    v_permlane16_swap_b32 v14, v134
    v_permlane16_swap_b32 v15, v135
    v_add_f32 v12, v12, v132
    v_add_f32 v13, v13, v133
    v_add_f32 v14, v14, v134
    v_add_f32 v15, v15, v135
    v_mov_b32 v132, v12
    v_mov_b32 v133, v13
    v_mov_b32 v134, v14
    v_mov_b32 v135, v15
    v_permlane32_swap_b32 v12, v132
    v_permlane32_swap_b32 v13, v133
    v_permlane32_swap_b32 v14, v134
    v_permlane32_swap_b32 v15, v135
    v_add_f32 v12, v12, v132
    v_add_f32 v13, v13, v133
    v_add_f32 v14, v14, v134
    v_add_f32 v15, v15, v135
    v_add_u32 v12, 0x200, v12
    v_add_u32 v13, 0x200, v13
    v_add_u32 v14, 0x200, v14
    v_add_u32 v15, 0x200, v15
    v_bfi_b32 v12, v157, s52, v12
    v_bfi_b32 v13, v157, s67, v13
    v_bfi_b32 v14, v157, s52, v14
    v_bfi_b32 v15, v157, s67, v15
    s_lshl_b32 s61, s50, 10
    s_lshl_b32 s62, s74, 7
    s_add_u32 s61, s61, s62
    s_add_u32 s61, s61, 0x40000
    s_mov_b64 exec, 0xff
    buffer_store_dwordx4 v[12:15], v156, s[28:31], s61 offen sc1
    s_mov_b64 exec, -1
L_nob3:
L_ctl_93:
    s_cmp_gt_i32 s54, s80
    s_cbranch_scc1 L_fok_95
L_fp_96:
    ds_read_b64 v[144:145], v4
    s_sub_u32 s53, s53, 1
    s_cbranch_scc1 L_end
    s_waitcnt lgkmcnt(0)
    v_readfirstlane_b32 s54, v144
    v_readfirstlane_b32 s68, v145
    s_cmp_gt_i32 s54, s80
    s_cbranch_scc0 L_fp_96
L_fok_95:
    s_cmp_eq_u32 s78, 2
    s_cbranch_scc0 L_cs_94
    s_add_u32 s61, s58, s80
    v_mov_b32 v28, s61
    s_mov_b64 exec, 1
    buffer_store_dword v28, off, s[28:31], s79
    s_mov_b32 exec_lo, 0xffffffff
    s_mov_b32 exec_hi, 0x0
    buffer_load_dword v32, v29, s[28:31], 0 offen sc1
    s_waitcnt vmcnt(0)
    v_sub_u32 v32, v32, v31
    v_cmp_lt_u32 vcc, v32, v34
    s_nop 1
    v_cndmask_b32 v32, v30, v32, vcc
    s_mov_b64 exec, -1
    s_nop 0
    v_add_u32_dpp v32, v32, v32 row_ror:8 row_mask:0xf bank_mask:0xf
    s_nop 1
    v_add_u32_dpp v32, v32, v32 row_ror:4 row_mask:0xf bank_mask:0xf
    s_nop 1
    v_add_u32_dpp v32, v32, v32 row_ror:2 row_mask:0xf bank_mask:0xf
    s_nop 1
    v_add_u32_dpp v32, v32, v32 row_ror:1 row_mask:0xf bank_mask:0xf
    s_nop 0
    v_readlane_b32 s61, v32, 0
    v_readlane_b32 s62, v32, 16
    v_readlane_b32 s83, v32, 32
    s_add_u32 s61, s61, s62
    v_mov_b32 v32, 0
    s_lshl_b32 s61, s61, 3
    s_lshl_b32 s62, s80, 8
    s_sub_i32 s61, s61, s62
    s_add_i32 s61, s61, s82
    s_cmp_lt_i32 s61, -870
    s_cselect_b32 s62, 1, 0
    s_cmp_gt_i32 s61, -230
    s_cselect_b32 s62, 2, s62
    v_mov_b32 v144, s62
    ds_write_b32 v4, v144 offset:12
L_cs_94:
    s_add_u32 s80, s80, 4
    s_cmp_le_u32 s80, 48
    s_cbranch_scc1 L_ctl_93
L_ctl_93x:
    s_cmp_lt_u32 s50, 16
    s_cbranch_scc0 L_nob4
    v_and_b32 v146, 0x380, v148
L_b4poll:
    buffer_load_dwordx4 v[12:15], v146, s[28:31], s59 offen sc1
    s_sub_u32 s53, s53, 1
    s_cbranch_scc1 L_end
    s_waitcnt vmcnt(0)
    v_xor_b32 v12, s75, v12
    v_xor_b32 v13, s67, v13
    v_xor_b32 v14, s75, v14
    v_xor_b32 v15, s67, v15
    v_or3_b32 v144, v12, v13, v14
    v_bitop3_b32 v144, v144, v15, v157 bitop3:0xa8
    v_cmp_ne_u32 vcc, 0, v144
    s_nop 0
    s_cbranch_vccnz L_b4poll
    v_add_f32_dpp v12, v12, v12 row_ror:4 row_mask:0xf bank_mask:0xf
    v_add_f32_dpp v13, v13, v13 row_ror:4 row_mask:0xf bank_mask:0xf
    v_add_f32_dpp v14, v14, v14 row_ror:4 row_mask:0xf bank_mask:0xf
    v_add_f32_dpp v15, v15, v15 row_ror:4 row_mask:0xf bank_mask:0xf
    v_add_f32_dpp v12, v12, v12 row_ror:2 row_mask:0xf bank_mask:0xf
    v_add_f32_dpp v13, v13, v13 row_ror:2 row_mask:0xf bank_mask:0xf
    v_add_f32_dpp v14, v14, v14 row_ror:2 row_mask:0xf bank_mask:0xf
    v_add_f32_dpp v15, v15, v15 row_ror:2 row_mask:0xf bank_mask:0xf
    v_add_f32_dpp v12, v12, v12 row_ror:1 row_mask:0xf bank_mask:0xf
    v_add_f32_dpp v13, v13, v13 row_ror:1 row_mask:0xf bank_mask:0xf
    v_add_f32_dpp v14, v14, v14 row_ror:1 row_mask:0xf bank_mask:0xf
    v_add_f32_dpp v15, v15, v15 row_ror:1 row_mask:0xf bank_mask:0xf
    v_cvt_pk_bf16_f32 v12, v12, v12
    v_and_b32 v12, 0xffff0000, v12
    v_cvt_pk_bf16_f32 v13, v13, v13
    v_and_b32 v13, 0xffff0000, v13
    v_cvt_pk_bf16_f32 v14, v14, v14
    v_and_b32 v14, 0xffff0000, v14
    v_cvt_pk_bf16_f32 v15, v15, v15
    v_and_b32 v15, 0xffff0000, v15
    v_mul_f32 v132, s66, v12
    v_mul_f32 v133, s66, v13
    v_mul_f32 v134, s66, v14
    v_mul_f32 v135, s66, v15
    v_exp_f32 v132, -v132
    v_exp_f32 v133, -v133
    v_exp_f32 v134, -v134
    v_exp_f32 v135, -v135
    v_add_f32 v132, 1.0, v132
    v_add_f32 v133, 1.0, v133
    v_add_f32 v134, 1.0, v134
    v_add_f32 v135, 1.0, v135
    v_rcp_f32 v132, v132
    v_rcp_f32 v133, v133
    v_rcp_f32 v134, v134
    v_rcp_f32 v135, v135
    v_mul_f32 v12, v12, v132
    v_mul_f32 v13, v13, v133
    v_mul_f32 v14, v14, v134
    v_mul_f32 v15, v15, v135
    v_cvt_pk_bf16_f32 v12, v12, v12
    v_and_b32 v12, 0xffff0000, v12
    v_cvt_pk_bf16_f32 v13, v13, v13
    v_and_b32 v13, 0xffff0000, v13
    v_cvt_pk_bf16_f32 v14, v14, v14
    v_and_b32 v14, 0xffff0000, v14
    v_cvt_pk_bf16_f32 v15, v15, v15
    v_and_b32 v15, 0xffff0000, v15
    s_lshl_b32 s61, s76, 16
    v_mov_b32 v16, s61
    s_mov_b32 exec_lo, 0xffff0000
    s_mov_b32 exec_hi, 0x0
    s_and_b32 s61, s76, 0xffff0000
    v_mov_b32 v16, s61
    v_mov_b32 v12, v13
    s_mov_b32 exec_lo, 0x0
    s_mov_b32 exec_hi, 0xffff
    s_lshl_b32 s61, s77, 16
    v_mov_b32 v16, s61
    v_mov_b32 v12, v14
    s_mov_b32 exec_lo, 0x0
    s_mov_b32 exec_hi, 0xffff0000
    s_and_b32 s61, s77, 0xffff0000
    v_mov_b32 v16, s61
    v_mov_b32 v12, v15
    s_mov_b64 exec, -1
L_nob4:
L_ctl_97:
    s_cmp_gt_i32 s54, s80
    s_cbranch_scc1 L_fok_99
L_fp_100:
    ds_read_b64 v[144:145], v4
    s_sub_u32 s53, s53, 1
    s_cbranch_scc1 L_end
    s_waitcnt lgkmcnt(0)
    v_readfirstlane_b32 s54, v144
    v_readfirstlane_b32 s68, v145
    s_cmp_gt_i32 s54, s80
    s_cbranch_scc0 L_fp_100
L_fok_99:
    s_cmp_eq_u32 s78, 2
    s_cbranch_scc0 L_cs_98
    s_add_u32 s61, s58, s80
    v_mov_b32 v28, s61
    s_mov_b64 exec, 1
    buffer_store_dword v28, off, s[28:31], s79
    s_mov_b32 exec_lo, 0xffffffff
    s_mov_b32 exec_hi, 0x0
    buffer_load_dword v32, v29, s[28:31], 0 offen sc1
    s_waitcnt vmcnt(0)
    v_sub_u32 v32, v32, v31
    v_cmp_lt_u32 vcc, v32, v34
    s_nop 1
    v_cndmask_b32 v32, v30, v32, vcc
    s_mov_b64 exec, -1
    s_nop 0
    v_add_u32_dpp v32, v32, v32 row_ror:8 row_mask:0xf bank_mask:0xf
    s_nop 1
    v_add_u32_dpp v32, v32, v32 row_ror:4 row_mask:0xf bank_mask:0xf
    s_nop 1
    v_add_u32_dpp v32, v32, v32 row_ror:2 row_mask:0xf bank_mask:0xf
    s_nop 1
    v_add_u32_dpp v32, v32, v32 row_ror:1 row_mask:0xf bank_mask:0xf
    s_nop 0
    v_readlane_b32 s61, v32, 0
    v_readlane_b32 s62, v32, 16
    v_readlane_b32 s83, v32, 32
    s_add_u32 s61, s61, s62
    v_mov_b32 v32, 0
    s_lshl_b32 s61, s61, 3
    s_lshl_b32 s62, s80, 8
    s_sub_i32 s61, s61, s62
    s_add_i32 s61, s61, s82
    s_cmp_lt_i32 s61, -870
    s_cselect_b32 s62, 1, 0
    s_cmp_gt_i32 s61, -230
    s_cselect_b32 s62, 2, s62
    v_mov_b32 v144, s62
    ds_write_b32 v4, v144 offset:12
L_cs_98:
    s_add_u32 s80, s80, 4
    s_cmp_le_u32 s80, 84
    s_cbranch_scc1 L_ctl_97
L_ctl_97x:
    s_lshl_b32 s61, s48, 2
    s_lshr_b32 s62, s49, 3
    s_add_u32 s61, s61, s62
    s_lshl_b32 s61, s61, 9
    s_add_u32 s62, s61, 0x58000
L_mlpoll:
    buffer_load_dwordx4 v[100:103], v150, s[28:31], s62 offen offset:0 sc1
    buffer_load_dwordx4 v[104:107], v150, s[28:31], s62 offen offset:256 sc1
    s_sub_u32 s53, s53, 1
    s_cbranch_scc1 L_end
    s_waitcnt vmcnt(0)
    v_xor_b32 v100, s75, v100
    v_xor_b32 v101, s67, v101
    v_xor_b32 v102, s75, v102
    v_xor_b32 v103, s67, v103
    v_xor_b32 v104, s75, v104
    v_xor_b32 v105, s67, v105
    v_xor_b32 v106, s75, v106
    v_xor_b32 v107, s67, v107
    v_or3_b32 v144, v100, v101, v102
    v_or3_b32 v144, v144, v103, v104
    v_or3_b32 v144, v144, v105, v106
    v_bitop3_b32 v144, v144, v107, v157 bitop3:0xa8
    v_cmp_ne_u32 vcc, 0, v144
    s_nop 0
    s_cbranch_vccnz L_mlpoll
    v_and_b32 v140, 0xffff0000, v100
    v_and_b32 v142, 0xffff0000, v104
    v_max_f32 v8, v140, v142
    s_nop 1
    v_max_f32_dpp v8, v8, v8 row_ror:4 row_mask:0xf bank_mask:0xf
    s_nop 1
    v_max_f32_dpp v8, v8, v8 row_ror:8 row_mask:0xf bank_mask:0xf
    v_mov_b32 v145, v8
    s_nop 1
    v_permlane16_swap_b32 v8, v145
    v_max_f32 v8, v8, v145
    v_mov_b32 v145, v8
    s_nop 1
    v_permlane32_swap_b32 v8, v145
    v_max_f32 v8, v8, v145
    v_sub_f32 v140, v140, v8
    v_sub_f32 v142, v142, v8
    v_mul_f32 v140, s66, v140
    v_mul_f32 v142, s66, v142
    v_exp_f32 v140, v140
    v_exp_f32 v142, v142
    v_mul_f32 v128, v140, v102
    v_fmac_f32 v128, v142, v106
    s_nop 1
    v_add_f32_dpp v128, v128, v128 row_ror:4 row_mask:0xf bank_mask:0xf
    s_nop 1
    v_add_f32_dpp v128, v128, v128 row_ror:8 row_mask:0xf bank_mask:0xf
    v_mov_b32 v145, v128
    s_nop 1
    v_permlane16_swap_b32 v128, v145
    v_add_f32 v128, v128, v145
    v_mov_b32 v145, v128
    s_nop 1
    v_permlane32_swap_b32 v128, v145
    v_add_f32 v128, v128, v145
    v_rcp_f32 v128, v128
    s_nop 0
    v_mul_f32 v140, v140, v128
    v_mul_f32 v142, v142, v128
    v_mov_b32 v144, 1
    ds_write2_b32 v186, v140, v142 offset0:0 offset1:1
    ds_write_b32 v5, v144 offset:48
L_ctl_101:
    s_cmp_gt_i32 s54, s80
    s_cbranch_scc1 L_fok_103
L_fp_104:
    ds_read_b64 v[144:145], v4
    s_sub_u32 s53, s53, 1
    s_cbranch_scc1 L_end
    s_waitcnt lgkmcnt(0)
    v_readfirstlane_b32 s54, v144
    v_readfirstlane_b32 s68, v145
    s_cmp_gt_i32 s54, s80
    s_cbranch_scc0 L_fp_104
L_fok_103:
    s_cmp_eq_u32 s78, 2
    s_cbranch_scc0 L_cs_102
    s_add_u32 s61, s58, s80
    v_mov_b32 v28, s61
    s_mov_b64 exec, 1
    buffer_store_dword v28, off, s[28:31], s79
    s_mov_b32 exec_lo, 0xffffffff
    s_mov_b32 exec_hi, 0x0
    buffer_load_dword v32, v29, s[28:31], 0 offen sc1
    s_waitcnt vmcnt(0)
    v_sub_u32 v32, v32, v31
    v_cmp_lt_u32 vcc, v32, v34
    s_nop 1
    v_cndmask_b32 v32, v30, v32, vcc
    s_mov_b64 exec, -1
    s_nop 0
    v_add_u32_dpp v32, v32, v32 row_ror:8 row_mask:0xf bank_mask:0xf
    s_nop 1
    v_add_u32_dpp v32, v32, v32 row_ror:4 row_mask:0xf bank_mask:0xf
    s_nop 1
    v_add_u32_dpp v32, v32, v32 row_ror:2 row_mask:0xf bank_mask:0xf
    s_nop 1
    v_add_u32_dpp v32, v32, v32 row_ror:1 row_mask:0xf bank_mask:0xf
    s_nop 0
    v_readlane_b32 s61, v32, 0
    v_readlane_b32 s62, v32, 16
    v_readlane_b32 s83, v32, 32
    s_add_u32 s61, s61, s62
    v_mov_b32 v32, 0
    s_lshl_b32 s61, s61, 3
    s_lshl_b32 s62, s80, 8
    s_sub_i32 s61, s61, s62
    s_add_i32 s61, s61, s82
    s_cmp_lt_i32 s61, -870
    s_cselect_b32 s62, 1, 0
    s_cmp_gt_i32 s61, -230
    s_cselect_b32 s62, 2, s62
    v_mov_b32 v144, s62
    ds_write_b32 v4, v144 offset:12
L_cs_102:
    s_add_u32 s80, s80, 4
    s_cmp_le_u32 s80, 108
    s_cbranch_scc1 L_ctl_101
L_ctl_101x:
L_ctl_105:
    s_cmp_gt_i32 s54, s80
    s_cbranch_scc1 L_fok_107
L_fp_108:
    ds_read_b64 v[144:145], v4
    s_sub_u32 s53, s53, 1
    s_cbranch_scc1 L_end
    s_waitcnt lgkmcnt(0)
    v_readfirstlane_b32 s54, v144
    v_readfirstlane_b32 s68, v145
    s_cmp_gt_i32 s54, s80
    s_cbranch_scc0 L_fp_108
L_fok_107:
    s_cmp_eq_u32 s78, 2
    s_cbranch_scc0 L_cs_106
    s_add_u32 s61, s58, s80
    v_mov_b32 v28, s61
    s_mov_b64 exec, 1
    buffer_store_dword v28, off, s[28:31], s79
    s_mov_b32 exec_lo, 0xffffffff
    s_mov_b32 exec_hi, 0x0
    buffer_load_dword v32, v29, s[28:31], 0 offen sc1
    s_waitcnt vmcnt(0)
    v_sub_u32 v32, v32, v31
    v_cmp_lt_u32 vcc, v32, v34
    s_nop 1
    v_cndmask_b32 v32, v30, v32, vcc
    s_mov_b64 exec, -1
    s_nop 0
    v_add_u32_dpp v32, v32, v32 row_ror:8 row_mask:0xf bank_mask:0xf
    s_nop 1
    v_add_u32_dpp v32, v32, v32 row_ror:4 row_mask:0xf bank_mask:0xf
    s_nop 1
    v_add_u32_dpp v32, v32, v32 row_ror:2 row_mask:0xf bank_mask:0xf
    s_nop 1
    v_add_u32_dpp v32, v32, v32 row_ror:1 row_mask:0xf bank_mask:0xf
    s_nop 0
    v_readlane_b32 s61, v32, 0
    v_readlane_b32 s62, v32, 16
    v_readlane_b32 s83, v32, 32
    s_add_u32 s61, s61, s62
    v_mov_b32 v32, 0
    s_lshl_b32 s61, s61, 3
    s_lshl_b32 s62, s80, 8
    s_sub_i32 s61, s61, s62
    s_add_i32 s61, s61, s82
    s_cmp_lt_i32 s61, -870
    s_cselect_b32 s62, 1, 0
    s_cmp_gt_i32 s61, -230
    s_cselect_b32 s62, 2, s62
    v_mov_b32 v144, s62
    ds_write_b32 v4, v144 offset:12
L_cs_106:
    s_add_u32 s80, s80, 4
    s_cmp_le_u32 s80, 116
    s_cbranch_scc1 L_ctl_105
L_ctl_105x:
L_tailh:
    s_lshl_b32 s63, s81, 3
    s_mov_b32 s78, 0x00010001
    s_mov_b32 s79, 0x00010001
    s_mov_b32 exec_hi, 0
    s_barrier
    ds_read_b128 v[92:95], v187 offset:0
    ds_read_b128 v[96:99], v187 offset:512
    ds_read_b128 v[100:103], v187 offset:1024
    ds_read_b128 v[104:107], v187 offset:1536
    s_waitcnt lgkmcnt(2)
    v_pk_add_f32 v[92:93], v[92:93], v[96:97]
    v_pk_add_f32 v[94:95], v[94:95], v[98:99]
    s_waitcnt lgkmcnt(0)
    v_pk_add_f32 v[100:101], v[100:101], v[104:105]
    v_pk_add_f32 v[102:103], v[102:103], v[106:107]
    v_pk_add_f32 v[92:93], v[92:93], v[100:101]
    v_pk_add_f32 v[94:95], v[94:95], v[102:103]
    v_add_u32 v92, 0x200, v92
    v_add_u32 v93, 0x200, v93
    v_add_u32 v94, 0x200, v94
    v_add_u32 v95, 0x200, v95
    v_bfi_b32 v92, v157, s52, v92
    v_bfi_b32 v93, v157, s67, v93
    v_bfi_b32 v94, v157, s52, v94
    v_bfi_b32 v95, v157, s67, v95
    buffer_store_dwordx4 v[92:95], v151, s[28:31], s56 offen sc1
    s_mov_b64 exec, -1
    s_cmp_lt_u32 s50, 16
    s_cbranch_scc0 L_hfin
    s_mov_b64 vcc, -1
    s_waitcnt vmcnt(0)
L_s3poll:
    s_mov_b64 exec, vcc
    buffer_load_dwordx4 v[60:63], v152, s[28:31], s57 offen sc1
    s_mov_b64 exec, -1
    s_sub_u32 s53, s53, 1
    s_cbranch_scc1 L_end
    s_waitcnt vmcnt(0)
    v_xor_b32 v76, s75, v60
    v_xor_b32 v77, s67, v61
    v_xor_b32 v78, s75, v62
    v_xor_b32 v79, s67, v63
    v_or3_b32 v144, v76, v77, v78
    v_bitop3_b32 v144, v144, v79, v157 bitop3:0xa8
    v_cmp_ne_u32 vcc, 0, v144
    s_nop 0
    s_cbranch_vccnz L_s3poll
    v_permlane16_swap_b32 v76, v77
    v_permlane16_swap_b32 v78, v79
    v_add_f32 v76, v76, v77
    v_add_f32 v78, v78, v79
    s_nop 1
    v_permlane32_swap_b32 v76, v78
    v_add_f32 v76, v76, v78
    s_nop 1
    v_add_f32_dpp v76, v76, v76 row_ror:8 row_mask:0xf bank_mask:0xf
    s_nop 1
    v_add_f32_dpp v76, v76, v76 row_ror:4 row_mask:0xf bank_mask:0xf
    s_nop 1
    v_add_f32_dpp v76, v76, v76 row_ror:2 row_mask:0xf bank_mask:0xf
    s_nop 1
    v_add_f32_dpp v76, v76, v76 row_ror:1 row_mask:0xf bank_mask:0xf
    v_cvt_pk_bf16_f32 v76, v76, v76
    v_and_b32 v76, 0xffff0000, v76
    v_mul_f32 v76, v76, v12
    v_cvt_pk_bf16_f32 v76, v76, v76
    v_and_b32 v76, 0xffff0000, v76
    v_add_f32 v76, v76, v16
    v_cvt_pk_bf16_f32 v76, v76, v76
    s_mov_b64 exec, s[78:79]
    buffer_store_short v76, v17, s[44:47], s63 offen
    s_mov_b64 exec, 1
    s_cmp_eq_u32 s81, 0
    s_cbranch_scc0 L_hfin
    v_mov_b32 v145, s52
    buffer_store_dword v145, off, s[28:31], 0
L_hfin:
    s_waitcnt vmcnt(0)
L_end:
    s_endpgm
.section .rodata,"a"
.p2align 6
.amdhsa_kernel recurrent_scan__gqa_block_cached__geglu_ffn__decode_kernel
  .amdhsa_next_free_vgpr 256
  .amdhsa_next_free_sgpr 96
  .amdhsa_accum_offset 256
  .amdhsa_group_segment_fixed_size 0
  .amdhsa_kernarg_size 96
  .amdhsa_user_sgpr_count 2
  .amdhsa_user_sgpr_kernarg_segment_ptr 1
  .amdhsa_system_sgpr_workgroup_id_x 1
  .amdhsa_float_denorm_mode_32 3
.end_amdhsa_kernel
```
